```python
import torch

def _softmax(x, axis=-1):
    return torch.softmax(x, dim=axis)
def _gelu(x):
    return torch.nn.functional.gelu(x, approximate="tanh")
def _silu(x):
    return torch.nn.functional.silu(x)
def _sigmoid(x):
    return torch.sigmoid(x)
def _layernorm(x, axis=-1, eps=1e-5):
    m = x.mean(dim=axis, keepdim=True)
    v = x.var(dim=axis, keepdim=True, unbiased=False)
    return (x - m) / torch.sqrt(v + eps)
def _scatter_add(tgt, idx, src, axis=0):
    return tgt.clone().index_add_(axis, idx, src)
def _segment_sum(src, seg, n):
    out = torch.zeros((n,) + src.shape[1:], dtype=src.dtype)
    return out.index_add_(0, seg, src)
def _pad(x, pw):
    flat = tuple(v for pair in reversed(pw) for v in pair)
    return torch.nn.functional.pad(x, flat)

kernel_name = 'gated_mix__ssm_conv_h3__dense_activation_gelu__prompt'

def setup_inputs():

    _w = (lambda a: (lambda t: t.to(torch.bfloat16) if t.is_floating_point() else t)(torch.as_tensor(a)))
    def _A_setup():
        B, S, D = 1, 2048, 640
        ks = 4
        return {
            "q": _w((lambda *s: torch.randn(*s, dtype=torch.bfloat16) * 0.05)(B, S, D)),
            "k": _w((lambda *s: torch.randn(*s, dtype=torch.bfloat16) * 0.2)(B, S, D)),
            "v": _w((lambda *s: torch.randn(*s, dtype=torch.bfloat16) * 0.2)(B, S, D)),
            "shift_k": _w((lambda *s: torch.randn(*s, dtype=torch.bfloat16) * 0.2)(D, ks) * 0.5),
            "ssm_k": _w((lambda *s: torch.randn(*s, dtype=torch.bfloat16) * 0.8)(D, S) * (1.0 / S ** 0.5)),
            "ssm_D": _w((lambda *s: torch.randn(*s, dtype=torch.bfloat16) * 0.2)(D)),
        }
    _A_in = _A_setup()

    def _B_setup():
        B, S, D, F = 1, 2048, 640, 1536
        return {
            "x": _w((lambda *s: torch.randn(*s, dtype=torch.bfloat16) * 0.05)(B, S, D)),
            "w1": _w((lambda *s: torch.randn(*s, dtype=torch.bfloat16) * 3.2)(D, F) * (D ** -0.5)),
            "b1": _w((lambda *s: torch.randn(*s, dtype=torch.bfloat16) * 3.2)(F) * 0.01),
            "w2": _w((lambda *s: torch.randn(*s, dtype=torch.bfloat16) * 0.05)(F, D) * (F ** -0.5)),
            "b2": _w((lambda *s: torch.randn(*s, dtype=torch.bfloat16) * 0.1)(D) * 0.01),
        }
    _B_in = _B_setup()

    return {
        "A_q": _A_in["q"],
        "A_k": _A_in["k"],
        "A_v": _A_in["v"],
        "A_shift_k": _A_in["shift_k"],
        "A_ssm_k": _A_in["ssm_k"],
        "A_ssm_D": _A_in["ssm_D"],
        "B_x": _B_in["x"],
        "B_w1": _B_in["w1"],
        "B_b1": _B_in["b1"],
        "B_w2": _B_in["w2"],
        "B_b2": _B_in["b2"],
        "gate_w": _w((lambda *s: torch.randn(*s, dtype=torch.bfloat16) * 0.05)(640) * 16.0),
    }

def reference(A_q, A_k, A_v, A_shift_k, A_ssm_k, A_ssm_D, B_x, B_w1, B_b1, B_w2, B_b2, gate_w):
    def _A_ref(q, k, v, shift_k, ssm_k, ssm_D):
        B, S, D = q.shape
        ks = shift_k.shape[-1]
        k_pad = _pad(k, ((0, 0), (ks - 1, 0), (0, 0)))
        k_shift = torch.zeros_like(k)
        for t in range(ks):
            k_shift = k_shift + k_pad[:, t:t + S, :] * shift_k[:, ks - 1 - t][None, None, :]
        kv = k_shift * v
        L = 2 * S
        kv_pad = _pad(kv, ((0, 0), (0, S), (0, 0)))
        kf_pad = _pad(ssm_k, ((0, 0), (0, S)))
        kv_f = (lambda x, axes=(-2,-1): torch.fft.rfft2(x.float(), dim=axes))(kv_pad[:, None, :, :], axes=(1, 2))
        kf_f = (lambda x, axes=(-2,-1): torch.fft.rfft2(x.float(), dim=axes))(kf_pad[:, None, :], axes=(1, 2))
        kf_f = (lambda x, *d: x.permute(*d))(kf_f, 1, 2, 0)
        y_f = kv_f * kf_f[None, :, :, :]
        y = (lambda x, s, axes=(-2,-1): torch.fft.irfft2(x, s=s, dim=axes).to(torch.bfloat16))(y_f, (1, L), axes=(1, 2))[:, 0, :S, :]
        y = y + kv * ssm_D[None, None, :]
        return q * y

    def _B_ref(x, w1, b1, w2, b2):
        h = torch.einsum("bsd,df->bsf", x, w1) + b1
        h = _gelu(h)
        return torch.einsum("bsf,fd->bsd", h, w2) + b2

    x = A_q
    g = _sigmoid((x * gate_w).sum(-1, keepdims=True))
    a = _A_ref(x, A_k, A_v, A_shift_k, A_ssm_k, A_ssm_D)
    b = _B_ref(x, B_w1, B_b1, B_w2, B_b2)
    return g * a + (1 - g) * b
```

```asm
; @launch grid=(256,1,1) block=(256,1,1) lds=163840
.amdgcn_target "amdgcn-amd-amdhsa--gfx950"
.text
.globl gated_mix__ssm_conv_h3__dense_activation_gelu__prompt_kernel
.p2align 8
.type gated_mix__ssm_conv_h3__dense_activation_gelu__prompt_kernel,@function
gated_mix__ssm_conv_h3__dense_activation_gelu__prompt_kernel:
    s_cmp_ge_u32 s2, 256
    s_cbranch_scc1 END_gated_mix__ssm_conv_h3__dense_activation_gelu__prompt_kernel
    s_load_dwordx16 s[16:31], s[0:1], 0
    s_load_dwordx8 s[32:39], s[0:1], 64
    s_load_dwordx4 s[40:43], s[0:1], 96
    s_load_dwordx2 s[44:45], s[0:1], 112
    s_and_b32 s3, s2, 7
    s_lshr_b32 s4, s2, 3
    s_getpc_b64 s[12:13]
    s_and_b32 s14, s4, 7
    s_min_u32 s14, s14, 6
    s_lshl_b32 s14, s14, 12
    s_add_u32 s12, s12, s14
    s_addc_u32 s13, s13, 0
    v_lshlrev_b32 v2, 4, v0
    v_mov_b32 v3, s13
    v_add_co_u32 v2, vcc, s12, v2
    s_nop 1
    v_addc_co_u32 v3, vcc, 0, v3, vcc
    global_load_dwordx4 v[252:255], v[2:3], off
    v_lshrrev_b32 v2, 6, v0
    v_and_b32 v1, 63, v0
    s_and_b32 s5, s4, 3
    v_readfirstlane_b32 s9, v2
    s_lshl_b32 s80, s3, 2
    s_lshr_b32 s6, s4, 2
    s_lshr_b32 s7, s3, 1
    s_lshl_b32 s7, s7, 2
    s_add_u32 s7, s7, s5
    s_and_b32 s8, s3, 1
    s_lshl_b32 s8, s8, 3
    s_add_u32 s8, s8, s6
    s_mul_i32 s15, s5, 3
    s_add_u32 s15, s15, s6
    s_sub_u32 s14, s15, 10
    s_cmp_ge_u32 s15, 10
    s_cselect_b32 s15, s14, s15
    s_add_u32 s5, s5, s80
    s_waitcnt lgkmcnt(0)
    s_mov_b32 s52, s18
    s_and_b32 s53, s19, 0xffff
    s_mov_b32 s54, 0x280000
    s_mov_b32 s55, 0x20000
    s_mov_b32 s56, s20
    s_and_b32 s57, s21, 0xffff
    s_mov_b32 s58, 0x280000
    s_mov_b32 s59, 0x20000
    s_mov_b32 s64, s34
    s_and_b32 s65, s35, 0xffff
    s_mov_b32 s66, 0x1e0000
    s_mov_b32 s67, 0x20000
    s_cmp_eq_u32 s9, 3
    s_cbranch_scc1 L_gate_1
    v_mul_u32_u24 v12, 6554, v0
    v_lshrrev_b32 v12, 16, v12
    v_mul_u32_u24 v13, 10, v12
    v_sub_u32 v13, v0, v13
    s_mul_i32 s80, s5, 81920
    s_mul_i32 s81, s6, 160
    s_add_u32 s80, s80, s81
    v_mul_u32_u24 v4, 5120, v12
    v_lshl_add_u32 v4, v13, 4, v4
    v_add_u32 v4, s80, v4
    v_subrev_u32 v5, 3840, v4
    s_mul_i32 s81, s6, 640
    v_lshlrev_b32 v6, 6, v13
    v_add_u32 v6, s81, v6
    v_cmp_gt_u32 vcc, 160, v0
    s_nop 0
    s_and_saveexec_b64 s[82:83], vcc
    buffer_load_dwordx4 v[132:135], v4, s[52:55], 0 offen offset:0 nt
    buffer_load_dwordx4 v[136:139], v4, s[52:55], 0 offen offset:1280 nt
    buffer_load_dwordx4 v[140:143], v4, s[52:55], 0 offen offset:2560 nt
    buffer_load_dwordx4 v[144:147], v4, s[52:55], 0 offen offset:3840 nt
    buffer_load_dwordx4 v[148:151], v4, s[56:59], 0 offen offset:0 nt
    buffer_load_dwordx4 v[152:155], v4, s[56:59], 0 offen offset:1280 nt
    buffer_load_dwordx4 v[156:159], v4, s[56:59], 0 offen offset:2560 nt
    buffer_load_dwordx4 v[160:163], v4, s[56:59], 0 offen offset:3840 nt
    buffer_load_dwordx4 a[0:3], v4, s[64:67], 0 offen offset:0 nt
    buffer_load_dwordx4 a[4:7], v4, s[64:67], 0 offen offset:1280 nt
    buffer_load_dwordx4 a[8:11], v4, s[64:67], 0 offen offset:2560 nt
    buffer_load_dwordx4 a[12:15], v4, s[64:67], 0 offen offset:3840 nt
    global_load_dwordx4 v[164:167], v6, s[22:23] offset:0
    global_load_dwordx4 v[168:171], v6, s[22:23] offset:16
    global_load_dwordx4 v[172:175], v6, s[22:23] offset:32
    global_load_dwordx4 v[176:179], v6, s[22:23] offset:48
    buffer_load_dwordx4 v[120:123], v5, s[52:55], 0 offen offset:0 nt
    buffer_load_dwordx4 v[124:127], v5, s[52:55], 0 offen offset:1280 nt
    buffer_load_dwordx4 v[128:131], v5, s[52:55], 0 offen offset:2560 nt
    s_mov_b64 exec, s[82:83]
    s_branch L_pl_2
L_gate_1:
L_pl_2:
    s_cmp_ge_u32 s2, 8
    s_cbranch_scc1 L_tokp_3
    s_cmp_lg_u32 s9, 3
    s_cbranch_scc1 L_tokp_3
    s_memrealtime s[12:13]
    s_waitcnt lgkmcnt(0)
    s_or_b32 s12, s12, 1
    v_mov_b32 v4, s12
    v_mov_b32 v5, s13
    v_mov_b32 v6, 0
    v_mov_b32 v7, 0
    s_mov_b64 exec, 1
    global_atomic_cmpswap_x2 v6, v[4:7], s[42:43] sc1
    s_mov_b64 exec, -1
    s_nop 1
L_tokp_3:
    v_lshrrev_b32 v2, 3, v1
    v_and_b32 v3, 7, v1
    s_lshl_b32 s80, s7, 7
    s_lshl_b32 s81, s9, 5
    s_add_u32 s80, s80, s81
    s_mul_i32 s80, s80, 1280
    v_add_u32 v4, 0, v2
    v_bfe_u32 v5, v4, 1, 3
    v_xor_b32 v5, v5, v3
    v_mul_u32_u24 v4, 1280, v4
    v_lshl_add_u32 v4, v5, 4, v4
    v_add_u32 v4, s80, v4
    v_mov_b32 v16, v4
    v_add_u32 v18, 18432, v4
    v_add_u32 v4, 8, v2
    v_bfe_u32 v5, v4, 1, 3
    v_xor_b32 v5, v5, v3
    v_mul_u32_u24 v4, 1280, v4
    v_lshl_add_u32 v4, v5, 4, v4
    v_add_u32 v4, s80, v4
    v_subrev_u32 v17, 1024, v4
    v_add_u32 v19, 17408, v4
    s_mul_i32 s80, s9, 49152
    s_mul_i32 s81, s8, 192
    s_add_u32 s80, s80, s81
    v_add_u32 v4, 0, v1
    v_mul_u32_u24 v5, 5462, v4
    v_lshrrev_b32 v5, 16, v5
    v_mul_u32_u24 v6, 12, v5
    v_sub_u32 v6, v4, v6
    v_bfe_u32 v7, v5, 3, 1
    v_lshlrev_b32 v7, 1, v7
    v_sub_u32 v6, v6, v7
    v_add_u32 v7, 12, v6
    v_min_u32 v6, v6, v7
    v_mul_u32_u24 v5, 3072, v5
    v_lshl_add_u32 v5, v6, 4, v5
    v_add_u32 v5, s80, v5
    v_subrev_u32 v20, 0, v5
    v_add_u32 v4, 64, v1
    v_mul_u32_u24 v5, 5462, v4
    v_lshrrev_b32 v5, 16, v5
    v_mul_u32_u24 v6, 12, v5
    v_sub_u32 v6, v4, v6
    v_bfe_u32 v7, v5, 3, 1
    v_lshlrev_b32 v7, 1, v7
    v_sub_u32 v6, v6, v7
    v_add_u32 v7, 12, v6
    v_min_u32 v6, v6, v7
    v_mul_u32_u24 v5, 3072, v5
    v_lshl_add_u32 v5, v6, 4, v5
    v_add_u32 v5, s80, v5
    v_subrev_u32 v21, 1024, v5
    v_add_u32 v4, 128, v1
    v_mul_u32_u24 v5, 5462, v4
    v_lshrrev_b32 v5, 16, v5
    v_mul_u32_u24 v6, 12, v5
    v_sub_u32 v6, v4, v6
    v_bfe_u32 v7, v5, 3, 1
    v_lshlrev_b32 v7, 1, v7
    v_sub_u32 v6, v6, v7
    v_add_u32 v7, 12, v6
    v_min_u32 v6, v6, v7
    v_mul_u32_u24 v5, 3072, v5
    v_lshl_add_u32 v5, v6, 4, v5
    v_add_u32 v5, s80, v5
    v_subrev_u32 v22, 2048, v5
    s_lshl_b32 s96, s15, 7
    s_mul_i32 s97, s15, 196608
    s_lshl_b32 s98, s9, 12
    s_mul_i32 s99, s9, 3072
    s_add_u32 s99, s99, 16384
    s_mov_b32 s48, s16
    s_and_b32 s49, s17, 0xffff
    s_mov_b32 s50, 0x280000
    s_mov_b32 s51, 0x20000
    s_mov_b32 s60, s30
    s_and_b32 s61, s31, 0xffff
    s_mov_b32 s62, 0x1e0000
    s_mov_b32 s63, 0x20000
    s_mov_b32 s68, s44
    s_and_b32 s69, s45, 0xffff
    s_mov_b32 s70, 0x10000000
    s_mov_b32 s71, 0x20000
    s_mov_b32 s72, s40
    s_and_b32 s73, s41, 0xffff
    s_mov_b32 s74, 0x280000
    s_mov_b32 s75, 0x20000
    v_lshrrev_b32 v3, 4, v1
    s_mul_i32 s80, s8, 192
    v_lshlrev_b32 v4, 3, v3
    v_add_u32 v4, s80, v4
    global_load_dwordx2 v[108:109], v4, s[32:33] offset:0
    global_load_dwordx2 v[110:111], v4, s[32:33] offset:32
    global_load_dwordx2 v[112:113], v4, s[32:33] offset:64
    global_load_dwordx2 v[114:115], v4, s[32:33] offset:96
    global_load_dwordx2 v[116:117], v4, s[32:33] offset:128
    global_load_dwordx2 v[118:119], v4, s[32:33] offset:160
    s_add_u32 m0, s98, 20480
    s_nop 0
    buffer_load_dwordx4 v16, s[48:51], s96 offen lds
    buffer_load_dwordx4 v17, s[48:51], s96 offen offset:1024 lds
    buffer_load_dwordx4 v18, s[48:51], s96 offen offset:2048 lds
    buffer_load_dwordx4 v19, s[48:51], s96 offen offset:3072 lds
    s_add_u32 m0, s99, 20480
    s_add_u32 s96, s96, 128
    buffer_load_dwordx4 v20, s[60:63], s97 offen lds
    buffer_load_dwordx4 v21, s[60:63], s97 offen offset:1024 lds
    buffer_load_dwordx4 v22, s[60:63], s97 offen offset:2048 lds
    s_add_u32 s97, s97, 196608
    s_cmp_eq_u32 s96, 1280
    s_cmov_b32 s96, 0
    s_cmov_b32 s97, 0
    s_add_u32 m0, s98, 49152
    s_nop 0
    buffer_load_dwordx4 v16, s[48:51], s96 offen lds
    buffer_load_dwordx4 v17, s[48:51], s96 offen offset:1024 lds
    buffer_load_dwordx4 v18, s[48:51], s96 offen offset:2048 lds
    buffer_load_dwordx4 v19, s[48:51], s96 offen offset:3072 lds
    s_add_u32 m0, s99, 49152
    s_add_u32 s96, s96, 128
    buffer_load_dwordx4 v20, s[60:63], s97 offen lds
    buffer_load_dwordx4 v21, s[60:63], s97 offen offset:1024 lds
    buffer_load_dwordx4 v22, s[60:63], s97 offen offset:2048 lds
    s_add_u32 s97, s97, 196608
    s_cmp_eq_u32 s96, 1280
    s_cmov_b32 s96, 0
    s_cmov_b32 s97, 0
    s_add_u32 m0, s98, 77824
    s_nop 0
    buffer_load_dwordx4 v16, s[48:51], s96 offen lds
    buffer_load_dwordx4 v17, s[48:51], s96 offen offset:1024 lds
    buffer_load_dwordx4 v18, s[48:51], s96 offen offset:2048 lds
    buffer_load_dwordx4 v19, s[48:51], s96 offen offset:3072 lds
    s_add_u32 m0, s99, 77824
    s_add_u32 s96, s96, 128
    buffer_load_dwordx4 v20, s[60:63], s97 offen lds
    buffer_load_dwordx4 v21, s[60:63], s97 offen offset:1024 lds
    buffer_load_dwordx4 v22, s[60:63], s97 offen offset:2048 lds
    s_add_u32 s97, s97, 196608
    s_cmp_eq_u32 s96, 1280
    s_cmov_b32 s96, 0
    s_cmov_b32 s97, 0
    v_lshrrev_b32 v3, 4, v1
    v_and_b32 v2, 15, v1
    v_lshrrev_b32 v4, 1, v2
    v_xor_b32 v4, v4, v3
    v_lshlrev_b32 v4, 4, v4
    v_lshl_add_u32 v4, v2, 7, v4
    v_add_u32 v4, s98, v4
    v_xor_b32 v5, 64, v4
    v_lshrrev_b32 v6, 2, v2
    v_lshl_add_u32 v6, v3, 3, v6
    v_mul_u32_u24 v6, 192, v6
    v_and_b32 v7, 3, v1
    v_lshl_add_u32 v6, v7, 3, v6
    v_and_b32 v7, 1, v3
    v_lshl_add_u32 v6, v7, 5, v6
    v_mul_u32_u24 v7, 192, v7
    v_sub_u32 v7, v6, v7
    v_add_u32 v24, 20480, v4
    v_add_u32 v25, 20480, v5
    v_add_u32 v26, 36864, v6
    v_add_u32 v27, 36864, v7
    v_add_u32 v28, 77824, v4
    v_add_u32 v29, 77824, v5
    v_add_u32 v30, 94208, v6
    v_add_u32 v31, 94208, v7
    v_add_u32 v32, 135168, v4
    v_add_u32 v33, 135168, v5
    v_add_u32 v34, 151552, v6
    v_add_u32 v35, 151552, v7
    v_mov_b32 v248, 0
    global_load_dwordx2 v[244:245], v248, s[42:43] sc1
    s_mul_i32 s80, s6, 80
    s_lshr_b32 s81, s5, 1
    s_mul_i32 s81, s81, 5
    s_add_u32 s80, s80, s81
    s_and_b32 s81, s5, 1
    s_mul_i32 s81, s81, 3
    s_add_u32 s90, s80, s81
    s_add_u32 s91, s90, 1
    s_add_u32 s92, s80, 2
    s_cmp_eq_u32 s9, 1
    s_cselect_b32 s83, s91, s90
    s_cmp_eq_u32 s9, 2
    s_cselect_b32 s83, s92, s83
    s_lshr_b32 s80, s83, 1
    s_lshl_b32 s80, s80, 2
    s_load_dword s93, s[26:27], s80
    s_lshr_b32 s80, s91, 1
    s_lshl_b32 s80, s80, 2
    s_load_dword s94, s[26:27], s80
    s_waitcnt vmcnt(22)
    v_lshlrev_b32 v84, 16, v108
    v_and_b32 v85, 0xffff0000, v108
    v_lshlrev_b32 v86, 16, v109
    v_and_b32 v87, 0xffff0000, v109
    v_lshlrev_b32 v88, 16, v110
    v_and_b32 v89, 0xffff0000, v110
    v_lshlrev_b32 v90, 16, v111
    v_and_b32 v91, 0xffff0000, v111
    v_lshlrev_b32 v92, 16, v112
    v_and_b32 v93, 0xffff0000, v112
    v_lshlrev_b32 v94, 16, v113
    v_and_b32 v95, 0xffff0000, v113
    v_lshlrev_b32 v96, 16, v114
    v_and_b32 v97, 0xffff0000, v114
    v_lshlrev_b32 v98, 16, v115
    v_and_b32 v99, 0xffff0000, v115
    v_lshlrev_b32 v100, 16, v116
    v_and_b32 v101, 0xffff0000, v116
    v_lshlrev_b32 v102, 16, v117
    v_and_b32 v103, 0xffff0000, v117
    v_lshlrev_b32 v104, 16, v118
    v_and_b32 v105, 0xffff0000, v118
    v_lshlrev_b32 v106, 16, v119
    v_and_b32 v107, 0xffff0000, v119
    s_waitcnt lgkmcnt(0)
    s_waitcnt vmcnt(15)
    s_barrier
    ds_read_b128 a[240:243], v24 offset:0
    ds_read_b128 a[244:247], v24 offset:2048
    ds_read_b64_tr_b16 a[192:193], v26 offset:0
    ds_read_b64_tr_b16 a[194:195], v26 offset:768
    ds_read_b64_tr_b16 a[196:197], v26 offset:32
    ds_read_b64_tr_b16 a[198:199], v26 offset:800
    ds_read_b64_tr_b16 a[200:201], v26 offset:64
    ds_read_b64_tr_b16 a[202:203], v26 offset:832
    ds_read_b64_tr_b16 a[204:205], v26 offset:96
    ds_read_b64_tr_b16 a[206:207], v26 offset:864
    ds_read_b64_tr_b16 a[208:209], v26 offset:128
    ds_read_b64_tr_b16 a[210:211], v26 offset:896
    ds_read_b64_tr_b16 a[212:213], v27 offset:160
    ds_read_b64_tr_b16 a[214:215], v27 offset:928
    s_add_u32 m0, s98, 106496
    s_nop 0
    buffer_load_dwordx4 v16, s[48:51], s96 offen lds
    buffer_load_dwordx4 v17, s[48:51], s96 offen offset:1024 lds
    buffer_load_dwordx4 v18, s[48:51], s96 offen offset:2048 lds
    buffer_load_dwordx4 v19, s[48:51], s96 offen offset:3072 lds
    s_waitcnt lgkmcnt(10)
    v_mfma_f32_16x16x32_bf16 v[36:39], a[192:195], a[240:243], v[84:87]
    ds_read_b128 a[248:251], v25 offset:0
    ds_read_b128 a[252:255], v25 offset:2048
    v_mfma_f32_16x16x32_bf16 v[40:43], a[192:195], a[244:247], v[84:87]
    ds_read_b64_tr_b16 a[216:217], v26 offset:6144
    ds_read_b64_tr_b16 a[218:219], v26 offset:6912
    s_waitcnt lgkmcnt(12)
    v_mfma_f32_16x16x32_bf16 v[44:47], a[196:199], a[240:243], v[88:91]
    ds_read_b64_tr_b16 a[220:221], v26 offset:6176
    ds_read_b64_tr_b16 a[222:223], v26 offset:6944
    v_mfma_f32_16x16x32_bf16 v[48:51], a[196:199], a[244:247], v[88:91]
    ds_read_b64_tr_b16 a[224:225], v26 offset:6208
    ds_read_b64_tr_b16 a[226:227], v26 offset:6976
    s_waitcnt lgkmcnt(14)
    v_mfma_f32_16x16x32_bf16 v[52:55], a[200:203], a[240:243], v[92:95]
    ds_read_b64_tr_b16 a[228:229], v26 offset:6240
    ds_read_b64_tr_b16 a[230:231], v26 offset:7008
    v_mfma_f32_16x16x32_bf16 v[56:59], a[200:203], a[244:247], v[92:95]
    ds_read_b64_tr_b16 a[232:233], v26 offset:6272
    ds_read_b64_tr_b16 a[234:235], v26 offset:7040
    s_waitcnt lgkmcnt(15)
    v_mfma_f32_16x16x32_bf16 v[60:63], a[204:207], a[240:243], v[96:99]
    ds_read_b64_tr_b16 a[236:237], v27 offset:6304
    ds_read_b64_tr_b16 a[238:239], v27 offset:7072
    v_mfma_f32_16x16x32_bf16 v[64:67], a[204:207], a[244:247], v[96:99]
    s_add_u32 m0, s99, 106496
    s_add_u32 s96, s96, 128
    buffer_load_dwordx4 v20, s[60:63], s97 offen lds
    s_waitcnt lgkmcnt(15)
    v_mfma_f32_16x16x32_bf16 v[68:71], a[208:211], a[240:243], v[100:103]
    buffer_load_dwordx4 v21, s[60:63], s97 offen offset:1024 lds
    v_mfma_f32_16x16x32_bf16 v[72:75], a[208:211], a[244:247], v[100:103]
    buffer_load_dwordx4 v22, s[60:63], s97 offen offset:2048 lds
    s_add_u32 s97, s97, 196608
    s_cmp_eq_u32 s96, 1280
    s_cmov_b32 s96, 0
    s_cmov_b32 s97, 0
    s_waitcnt lgkmcnt(14)
    v_mfma_f32_16x16x32_bf16 v[76:79], a[212:215], a[240:243], v[104:107]
    v_mfma_f32_16x16x32_bf16 v[80:83], a[212:215], a[244:247], v[104:107]
    s_waitcnt vmcnt(35)
    s_cmp_eq_u32 s9, 3
    s_cbranch_scc1 L_gate_4
    v_mul_u32_u24 v8, 640, v12
    v_lshlrev_b32 v9, 4, v13
    v_sub_u32 v7, v9, v8
    v_add_u32 v7, 9600, v7
    v_add_u32 v8, v8, v9
    v_add_u32 v8, 10240, v8
    v_cmp_gt_u32 vcc, 160, v0
    s_nop 0
    s_and_saveexec_b64 s[82:83], vcc
    ds_write_b128 v8, a[0:3] offset:0
    ds_write_b128 v8, a[4:7] offset:160
    ds_write_b128 v8, a[8:11] offset:320
    ds_write_b128 v8, a[12:15] offset:480
    v_lshlrev_b32 v180, 16, v120
    v_and_b32 v181, 0xffff0000, v120
    v_lshlrev_b32 v182, 16, v124
    v_and_b32 v183, 0xffff0000, v124
    v_lshlrev_b32 v184, 16, v128
    v_and_b32 v185, 0xffff0000, v128
    v_lshlrev_b32 v186, 16, v132
    v_and_b32 v187, 0xffff0000, v132
    v_lshlrev_b32 v188, 16, v136
    v_and_b32 v189, 0xffff0000, v136
    v_lshlrev_b32 v190, 16, v140
    v_and_b32 v191, 0xffff0000, v140
    v_lshlrev_b32 v192, 16, v144
    v_and_b32 v193, 0xffff0000, v144
    v_lshlrev_b32 v194, 16, v164
    v_and_b32 v196, 0xffff0000, v164
    v_lshlrev_b32 v198, 16, v165
    v_and_b32 v200, 0xffff0000, v165
    v_lshlrev_b32 v195, 16, v166
    v_and_b32 v197, 0xffff0000, v166
    v_lshlrev_b32 v199, 16, v167
    v_and_b32 v201, 0xffff0000, v167
    v_lshlrev_b32 v202, 16, v148
    v_and_b32 v203, 0xffff0000, v148
    v_lshlrev_b32 v204, 16, v152
    v_and_b32 v205, 0xffff0000, v152
    v_lshlrev_b32 v206, 16, v156
    v_and_b32 v207, 0xffff0000, v156
    v_lshlrev_b32 v208, 16, v160
    v_and_b32 v209, 0xffff0000, v160
    v_pk_mul_f32 v[210:211], v[186:187], v[194:195]
    v_pk_mul_f32 v[212:213], v[188:189], v[194:195]
    v_pk_mul_f32 v[214:215], v[190:191], v[194:195]
    v_pk_mul_f32 v[216:217], v[192:193], v[194:195]
    v_pk_fma_f32 v[210:211], v[184:185], v[196:197], v[210:211]
    v_pk_fma_f32 v[212:213], v[186:187], v[196:197], v[212:213]
    v_pk_fma_f32 v[214:215], v[188:189], v[196:197], v[214:215]
    v_pk_fma_f32 v[216:217], v[190:191], v[196:197], v[216:217]
    v_pk_fma_f32 v[210:211], v[182:183], v[198:199], v[210:211]
    v_pk_fma_f32 v[212:213], v[184:185], v[198:199], v[212:213]
    v_pk_fma_f32 v[214:215], v[186:187], v[198:199], v[214:215]
    v_pk_fma_f32 v[216:217], v[188:189], v[198:199], v[216:217]
    v_pk_fma_f32 v[210:211], v[180:181], v[200:201], v[210:211]
    v_pk_fma_f32 v[212:213], v[182:183], v[200:201], v[212:213]
    v_pk_fma_f32 v[214:215], v[184:185], v[200:201], v[214:215]
    v_pk_fma_f32 v[216:217], v[186:187], v[200:201], v[216:217]
    v_pk_mul_f32 v[210:211], v[210:211], v[202:203]
    v_pk_mul_f32 v[212:213], v[212:213], v[204:205]
    v_pk_mul_f32 v[214:215], v[214:215], v[206:207]
    v_pk_mul_f32 v[216:217], v[216:217], v[208:209]
    v_cvt_pk_bf16_f32 v148, v210, v211
    v_cvt_pk_bf16_f32 v152, v212, v213
    v_cvt_pk_bf16_f32 v156, v214, v215
    v_cvt_pk_bf16_f32 v160, v216, v217
    v_lshlrev_b32 v180, 16, v121
    v_and_b32 v181, 0xffff0000, v121
    v_lshlrev_b32 v182, 16, v125
    v_and_b32 v183, 0xffff0000, v125
    v_lshlrev_b32 v184, 16, v129
    v_and_b32 v185, 0xffff0000, v129
    v_lshlrev_b32 v186, 16, v133
    v_and_b32 v187, 0xffff0000, v133
    v_lshlrev_b32 v188, 16, v137
    v_and_b32 v189, 0xffff0000, v137
    v_lshlrev_b32 v190, 16, v141
    v_and_b32 v191, 0xffff0000, v141
    v_lshlrev_b32 v192, 16, v145
    v_and_b32 v193, 0xffff0000, v145
    v_lshlrev_b32 v194, 16, v168
    v_and_b32 v196, 0xffff0000, v168
    v_lshlrev_b32 v198, 16, v169
    v_and_b32 v200, 0xffff0000, v169
    v_lshlrev_b32 v195, 16, v170
    v_and_b32 v197, 0xffff0000, v170
    v_lshlrev_b32 v199, 16, v171
    v_and_b32 v201, 0xffff0000, v171
    v_lshlrev_b32 v202, 16, v149
    v_and_b32 v203, 0xffff0000, v149
    v_lshlrev_b32 v204, 16, v153
    v_and_b32 v205, 0xffff0000, v153
    v_lshlrev_b32 v206, 16, v157
    v_and_b32 v207, 0xffff0000, v157
    v_lshlrev_b32 v208, 16, v161
    v_and_b32 v209, 0xffff0000, v161
    v_pk_mul_f32 v[210:211], v[186:187], v[194:195]
    v_pk_mul_f32 v[212:213], v[188:189], v[194:195]
    v_pk_mul_f32 v[214:215], v[190:191], v[194:195]
    v_pk_mul_f32 v[216:217], v[192:193], v[194:195]
    v_pk_fma_f32 v[210:211], v[184:185], v[196:197], v[210:211]
    v_pk_fma_f32 v[212:213], v[186:187], v[196:197], v[212:213]
    v_pk_fma_f32 v[214:215], v[188:189], v[196:197], v[214:215]
    v_pk_fma_f32 v[216:217], v[190:191], v[196:197], v[216:217]
    v_pk_fma_f32 v[210:211], v[182:183], v[198:199], v[210:211]
    v_pk_fma_f32 v[212:213], v[184:185], v[198:199], v[212:213]
    v_pk_fma_f32 v[214:215], v[186:187], v[198:199], v[214:215]
    v_pk_fma_f32 v[216:217], v[188:189], v[198:199], v[216:217]
    v_pk_fma_f32 v[210:211], v[180:181], v[200:201], v[210:211]
    v_pk_fma_f32 v[212:213], v[182:183], v[200:201], v[212:213]
    v_pk_fma_f32 v[214:215], v[184:185], v[200:201], v[214:215]
    v_pk_fma_f32 v[216:217], v[186:187], v[200:201], v[216:217]
    v_pk_mul_f32 v[210:211], v[210:211], v[202:203]
    v_pk_mul_f32 v[212:213], v[212:213], v[204:205]
    v_pk_mul_f32 v[214:215], v[214:215], v[206:207]
    v_pk_mul_f32 v[216:217], v[216:217], v[208:209]
    v_cvt_pk_bf16_f32 v149, v210, v211
    v_cvt_pk_bf16_f32 v153, v212, v213
    v_cvt_pk_bf16_f32 v157, v214, v215
    v_cvt_pk_bf16_f32 v161, v216, v217
    v_lshlrev_b32 v180, 16, v122
    v_and_b32 v181, 0xffff0000, v122
    v_lshlrev_b32 v182, 16, v126
    v_and_b32 v183, 0xffff0000, v126
    v_lshlrev_b32 v184, 16, v130
    v_and_b32 v185, 0xffff0000, v130
    v_lshlrev_b32 v186, 16, v134
    v_and_b32 v187, 0xffff0000, v134
    v_lshlrev_b32 v188, 16, v138
    v_and_b32 v189, 0xffff0000, v138
    v_lshlrev_b32 v190, 16, v142
    v_and_b32 v191, 0xffff0000, v142
    v_lshlrev_b32 v192, 16, v146
    v_and_b32 v193, 0xffff0000, v146
    v_lshlrev_b32 v194, 16, v172
    v_and_b32 v196, 0xffff0000, v172
    v_lshlrev_b32 v198, 16, v173
    v_and_b32 v200, 0xffff0000, v173
    v_lshlrev_b32 v195, 16, v174
    v_and_b32 v197, 0xffff0000, v174
    v_lshlrev_b32 v199, 16, v175
    v_and_b32 v201, 0xffff0000, v175
    v_lshlrev_b32 v202, 16, v150
    v_and_b32 v203, 0xffff0000, v150
    v_lshlrev_b32 v204, 16, v154
    v_and_b32 v205, 0xffff0000, v154
    v_lshlrev_b32 v206, 16, v158
    v_and_b32 v207, 0xffff0000, v158
    v_lshlrev_b32 v208, 16, v162
    v_and_b32 v209, 0xffff0000, v162
    v_pk_mul_f32 v[210:211], v[186:187], v[194:195]
    v_pk_mul_f32 v[212:213], v[188:189], v[194:195]
    v_pk_mul_f32 v[214:215], v[190:191], v[194:195]
    v_pk_mul_f32 v[216:217], v[192:193], v[194:195]
    v_pk_fma_f32 v[210:211], v[184:185], v[196:197], v[210:211]
    v_pk_fma_f32 v[212:213], v[186:187], v[196:197], v[212:213]
    v_pk_fma_f32 v[214:215], v[188:189], v[196:197], v[214:215]
    v_pk_fma_f32 v[216:217], v[190:191], v[196:197], v[216:217]
    v_pk_fma_f32 v[210:211], v[182:183], v[198:199], v[210:211]
    v_pk_fma_f32 v[212:213], v[184:185], v[198:199], v[212:213]
    v_pk_fma_f32 v[214:215], v[186:187], v[198:199], v[214:215]
    v_pk_fma_f32 v[216:217], v[188:189], v[198:199], v[216:217]
    v_pk_fma_f32 v[210:211], v[180:181], v[200:201], v[210:211]
    v_pk_fma_f32 v[212:213], v[182:183], v[200:201], v[212:213]
    v_pk_fma_f32 v[214:215], v[184:185], v[200:201], v[214:215]
    v_pk_fma_f32 v[216:217], v[186:187], v[200:201], v[216:217]
    v_pk_mul_f32 v[210:211], v[210:211], v[202:203]
    v_pk_mul_f32 v[212:213], v[212:213], v[204:205]
    v_pk_mul_f32 v[214:215], v[214:215], v[206:207]
    v_pk_mul_f32 v[216:217], v[216:217], v[208:209]
    v_cvt_pk_bf16_f32 v150, v210, v211
    v_cvt_pk_bf16_f32 v154, v212, v213
    v_cvt_pk_bf16_f32 v158, v214, v215
    v_cvt_pk_bf16_f32 v162, v216, v217
    v_lshlrev_b32 v180, 16, v123
    v_and_b32 v181, 0xffff0000, v123
    v_lshlrev_b32 v182, 16, v127
    v_and_b32 v183, 0xffff0000, v127
    v_lshlrev_b32 v184, 16, v131
    v_and_b32 v185, 0xffff0000, v131
    v_lshlrev_b32 v186, 16, v135
    v_and_b32 v187, 0xffff0000, v135
    v_lshlrev_b32 v188, 16, v139
    v_and_b32 v189, 0xffff0000, v139
    v_lshlrev_b32 v190, 16, v143
    v_and_b32 v191, 0xffff0000, v143
    v_lshlrev_b32 v192, 16, v147
    v_and_b32 v193, 0xffff0000, v147
    v_lshlrev_b32 v194, 16, v176
    v_and_b32 v196, 0xffff0000, v176
    v_lshlrev_b32 v198, 16, v177
    v_and_b32 v200, 0xffff0000, v177
    v_lshlrev_b32 v195, 16, v178
    v_and_b32 v197, 0xffff0000, v178
    v_lshlrev_b32 v199, 16, v179
    v_and_b32 v201, 0xffff0000, v179
    v_lshlrev_b32 v202, 16, v151
    v_and_b32 v203, 0xffff0000, v151
    v_lshlrev_b32 v204, 16, v155
    v_and_b32 v205, 0xffff0000, v155
    v_lshlrev_b32 v206, 16, v159
    v_and_b32 v207, 0xffff0000, v159
    v_lshlrev_b32 v208, 16, v163
    v_and_b32 v209, 0xffff0000, v163
    v_pk_mul_f32 v[210:211], v[186:187], v[194:195]
    v_pk_mul_f32 v[212:213], v[188:189], v[194:195]
    v_pk_mul_f32 v[214:215], v[190:191], v[194:195]
    v_pk_mul_f32 v[216:217], v[192:193], v[194:195]
    v_pk_fma_f32 v[210:211], v[184:185], v[196:197], v[210:211]
    v_pk_fma_f32 v[212:213], v[186:187], v[196:197], v[212:213]
    v_pk_fma_f32 v[214:215], v[188:189], v[196:197], v[214:215]
    v_pk_fma_f32 v[216:217], v[190:191], v[196:197], v[216:217]
    v_pk_fma_f32 v[210:211], v[182:183], v[198:199], v[210:211]
    v_pk_fma_f32 v[212:213], v[184:185], v[198:199], v[212:213]
    v_pk_fma_f32 v[214:215], v[186:187], v[198:199], v[214:215]
    v_pk_fma_f32 v[216:217], v[188:189], v[198:199], v[216:217]
    v_pk_fma_f32 v[210:211], v[180:181], v[200:201], v[210:211]
    v_pk_fma_f32 v[212:213], v[182:183], v[200:201], v[212:213]
    v_pk_fma_f32 v[214:215], v[184:185], v[200:201], v[214:215]
    v_pk_fma_f32 v[216:217], v[186:187], v[200:201], v[216:217]
    v_pk_mul_f32 v[210:211], v[210:211], v[202:203]
    v_pk_mul_f32 v[212:213], v[212:213], v[204:205]
    v_pk_mul_f32 v[214:215], v[214:215], v[206:207]
    v_pk_mul_f32 v[216:217], v[216:217], v[208:209]
    v_cvt_pk_bf16_f32 v151, v210, v211
    v_cvt_pk_bf16_f32 v155, v212, v213
    v_cvt_pk_bf16_f32 v159, v214, v215
    v_cvt_pk_bf16_f32 v163, v216, v217
    ds_write_b128 v7, v[148:151] offset:480
    ds_write_b128 v7, v[152:155] offset:320
    ds_write_b128 v7, v[156:159] offset:160
    ds_write_b128 v7, v[160:163] offset:0
    s_mov_b64 exec, s[82:83]
    s_branch L_prepjoin_5
L_gate_4:
L_prepjoin_5:
    s_waitcnt lgkmcnt(0)
    s_waitcnt vmcnt(15)
    s_barrier
    v_mfma_f32_16x16x32_bf16 v[36:39], a[216:219], a[248:251], v[36:39]
    ds_read_b128 a[240:243], v24 offset:28672
    ds_read_b128 a[244:247], v24 offset:30720
    v_mfma_f32_16x16x32_bf16 v[40:43], a[216:219], a[252:255], v[40:43]
    ds_read_b64_tr_b16 a[192:193], v26 offset:28672
    ds_read_b64_tr_b16 a[194:195], v26 offset:29440
    v_mfma_f32_16x16x32_bf16 v[44:47], a[220:223], a[248:251], v[44:47]
    ds_read_b64_tr_b16 a[196:197], v26 offset:28704
    ds_read_b64_tr_b16 a[198:199], v26 offset:29472
    v_mfma_f32_16x16x32_bf16 v[48:51], a[220:223], a[252:255], v[48:51]
    ds_read_b64_tr_b16 a[200:201], v26 offset:28736
    ds_read_b64_tr_b16 a[202:203], v26 offset:29504
    v_mfma_f32_16x16x32_bf16 v[52:55], a[224:227], a[248:251], v[52:55]
    ds_read_b64_tr_b16 a[204:205], v26 offset:28768
    ds_read_b64_tr_b16 a[206:207], v26 offset:29536
    v_mfma_f32_16x16x32_bf16 v[56:59], a[224:227], a[252:255], v[56:59]
    ds_read_b64_tr_b16 a[208:209], v26 offset:28800
    ds_read_b64_tr_b16 a[210:211], v26 offset:29568
    v_mfma_f32_16x16x32_bf16 v[60:63], a[228:231], a[248:251], v[60:63]
    ds_read_b64_tr_b16 a[212:213], v27 offset:28832
    ds_read_b64_tr_b16 a[214:215], v27 offset:29600
    v_mfma_f32_16x16x32_bf16 v[64:67], a[228:231], a[252:255], v[64:67]
    s_add_u32 m0, s98, 135168
    s_nop 0
    buffer_load_dwordx4 v16, s[48:51], s96 offen lds
    v_mfma_f32_16x16x32_bf16 v[68:71], a[232:235], a[248:251], v[68:71]
    buffer_load_dwordx4 v17, s[48:51], s96 offen offset:1024 lds
    v_mfma_f32_16x16x32_bf16 v[72:75], a[232:235], a[252:255], v[72:75]
    buffer_load_dwordx4 v18, s[48:51], s96 offen offset:2048 lds
    v_mfma_f32_16x16x32_bf16 v[76:79], a[236:239], a[248:251], v[76:79]
    buffer_load_dwordx4 v19, s[48:51], s96 offen offset:3072 lds
    v_mfma_f32_16x16x32_bf16 v[80:83], a[236:239], a[252:255], v[80:83]
    s_add_u32 m0, s99, 135168
    s_add_u32 s96, s96, 128
    buffer_load_dwordx4 v20, s[60:63], s97 offen lds
    v_and_b32 v2, 15, v1
    v_lshrrev_b32 v3, 4, v1
    v_lshrrev_b32 v4, 2, v2
    v_and_b32 v5, 3, v1
    s_and_b32 s80, s9, 1
    s_cmp_ge_u32 s9, 2
    s_cselect_b32 s81, 2, 3
    s_mov_b32 s82, 640
    s_cmov_b32 s82, 2560
    s_mov_b32 s83, 0
    s_cmov_b32 s83, 10240
    s_mov_b32 s84, 65536
    s_cmov_b32 s84, 1024
    s_mul_i32 s85, s80, 5120
    s_add_u32 s83, s83, s85
    v_lshlrev_b32 v6, s81, v3
    v_add_u32 v6, v6, v4
    v_mul_u32_u24 v6, 160, v6
    v_lshl_add_u32 v6, v5, 3, v6
    v_add_u32 v6, s83, v6
    v_add_u32 v7, s82, v6
    ds_read_b64_tr_b16 v[180:181], v6 offset:0
    ds_read_b64_tr_b16 v[182:183], v7 offset:0
    ds_read_b64_tr_b16 v[184:185], v6 offset:32
    ds_read_b64_tr_b16 v[186:187], v7 offset:32
    ds_read_b64_tr_b16 v[188:189], v6 offset:64
    ds_read_b64_tr_b16 v[190:191], v7 offset:64
    ds_read_b64_tr_b16 v[192:193], v6 offset:96
    ds_read_b64_tr_b16 v[194:195], v7 offset:96
    ds_read_b64_tr_b16 v[196:197], v6 offset:128
    ds_read_b64_tr_b16 v[198:199], v7 offset:128
    s_mul_i32 s85, s6, 327680
    s_lshl_b32 s86, s5, 7
    s_sub_u32 s85, s85, s86
    s_lshl_b32 s86, s80, 6
    s_add_u32 s85, s85, s86
    s_add_u32 s85, s85, 3968
    v_lshlrev_b32 v8, 12, v2
    v_lshl_add_u32 v8, v3, 4, v8
    s_mul_i32 s86, s6, 48
    s_lshl_b32 s87, s5, 1
    s_add_u32 s86, s86, s87
    s_add_u32 s86, s86, s80
    s_mul_i32 s86, s86, 5120
    s_add_u32 s86, s86, 0xc00000
    v_lshlrev_b32 v9, 4, v1
    s_cmp_ge_u32 s9, 2
    s_cselect_b32 s85, s86, s85
    s_cselect_b64 vcc, -1, 0
    v_cndmask_b32 v8, v8, v9, vcc
    s_cselect_b32 s87, s5, 0
    s_cmp_ge_u32 s87, 24
    s_waitcnt lgkmcnt(0)
    s_cbranch_scc1 L_prepskip_6
    buffer_store_dwordx4 v[180:183], v8, s[68:71], s85 offen sc1
    s_add_u32 s85, s85, s84
    buffer_store_dwordx4 v[184:187], v8, s[68:71], s85 offen sc1
    s_add_u32 s85, s85, s84
    buffer_store_dwordx4 v[188:191], v8, s[68:71], s85 offen sc1
    s_add_u32 s85, s85, s84
    buffer_store_dwordx4 v[192:195], v8, s[68:71], s85 offen sc1
    s_add_u32 s85, s85, s84
    buffer_store_dwordx4 v[196:199], v8, s[68:71], s85 offen sc1
L_prepskip_6:
    s_nop 1
    s_waitcnt lgkmcnt(15)
    v_mfma_f32_16x16x32_bf16 v[36:39], a[192:195], a[240:243], v[36:39]
    ds_read_b128 a[248:251], v25 offset:28672
    ds_read_b128 a[252:255], v25 offset:30720
    v_mfma_f32_16x16x32_bf16 v[40:43], a[192:195], a[244:247], v[40:43]
    ds_read_b64_tr_b16 a[216:217], v26 offset:34816
    ds_read_b64_tr_b16 a[218:219], v26 offset:35584
    s_waitcnt lgkmcnt(15)
    v_mfma_f32_16x16x32_bf16 v[44:47], a[196:199], a[240:243], v[44:47]
    ds_read_b64_tr_b16 a[220:221], v26 offset:34848
    ds_read_b64_tr_b16 a[222:223], v26 offset:35616
    v_mfma_f32_16x16x32_bf16 v[48:51], a[196:199], a[244:247], v[48:51]
    ds_read_b64_tr_b16 a[224:225], v26 offset:34880
    ds_read_b64_tr_b16 a[226:227], v26 offset:35648
    s_waitcnt lgkmcnt(15)
    v_mfma_f32_16x16x32_bf16 v[52:55], a[200:203], a[240:243], v[52:55]
    ds_read_b64_tr_b16 a[228:229], v26 offset:34912
    ds_read_b64_tr_b16 a[230:231], v26 offset:35680
    v_mfma_f32_16x16x32_bf16 v[56:59], a[200:203], a[244:247], v[56:59]
    ds_read_b64_tr_b16 a[232:233], v26 offset:34944
    ds_read_b64_tr_b16 a[234:235], v26 offset:35712
    s_waitcnt lgkmcnt(15)
    v_mfma_f32_16x16x32_bf16 v[60:63], a[204:207], a[240:243], v[60:63]
    ds_read_b64_tr_b16 a[236:237], v27 offset:34976
    ds_read_b64_tr_b16 a[238:239], v27 offset:35744
    v_mfma_f32_16x16x32_bf16 v[64:67], a[204:207], a[244:247], v[64:67]
    buffer_load_dwordx4 v21, s[60:63], s97 offen offset:1024 lds
    s_waitcnt lgkmcnt(15)
    v_mfma_f32_16x16x32_bf16 v[68:71], a[208:211], a[240:243], v[68:71]
    buffer_load_dwordx4 v22, s[60:63], s97 offen offset:2048 lds
    s_add_u32 s97, s97, 196608
    s_cmp_eq_u32 s96, 1280
    s_cmov_b32 s96, 0
    s_cmov_b32 s97, 0
    v_mfma_f32_16x16x32_bf16 v[72:75], a[208:211], a[244:247], v[72:75]
    s_waitcnt lgkmcnt(15)
    v_mfma_f32_16x16x32_bf16 v[76:79], a[212:215], a[240:243], v[76:79]
    v_mfma_f32_16x16x32_bf16 v[80:83], a[212:215], a[244:247], v[80:83]
    s_waitcnt lgkmcnt(0)
    s_waitcnt vmcnt(15)
    s_barrier
    v_mfma_f32_16x16x32_bf16 v[36:39], a[216:219], a[248:251], v[36:39]
    ds_read_b128 a[240:243], v28 offset:0
    ds_read_b128 a[244:247], v28 offset:2048
    v_mfma_f32_16x16x32_bf16 v[40:43], a[216:219], a[252:255], v[40:43]
    ds_read_b64_tr_b16 a[192:193], v30 offset:0
    ds_read_b64_tr_b16 a[194:195], v30 offset:768
    v_mfma_f32_16x16x32_bf16 v[44:47], a[220:223], a[248:251], v[44:47]
    ds_read_b64_tr_b16 a[196:197], v30 offset:32
    ds_read_b64_tr_b16 a[198:199], v30 offset:800
    v_mfma_f32_16x16x32_bf16 v[48:51], a[220:223], a[252:255], v[48:51]
    ds_read_b64_tr_b16 a[200:201], v30 offset:64
    ds_read_b64_tr_b16 a[202:203], v30 offset:832
    v_mfma_f32_16x16x32_bf16 v[52:55], a[224:227], a[248:251], v[52:55]
    ds_read_b64_tr_b16 a[204:205], v30 offset:96
    ds_read_b64_tr_b16 a[206:207], v30 offset:864
    v_mfma_f32_16x16x32_bf16 v[56:59], a[224:227], a[252:255], v[56:59]
    ds_read_b64_tr_b16 a[208:209], v30 offset:128
    ds_read_b64_tr_b16 a[210:211], v30 offset:896
    v_mfma_f32_16x16x32_bf16 v[60:63], a[228:231], a[248:251], v[60:63]
    ds_read_b64_tr_b16 a[212:213], v31 offset:160
    ds_read_b64_tr_b16 a[214:215], v31 offset:928
    v_mfma_f32_16x16x32_bf16 v[64:67], a[228:231], a[252:255], v[64:67]
    s_add_u32 m0, s98, 20480
    s_nop 0
    buffer_load_dwordx4 v16, s[48:51], s96 offen lds
    v_mfma_f32_16x16x32_bf16 v[68:71], a[232:235], a[248:251], v[68:71]
    buffer_load_dwordx4 v17, s[48:51], s96 offen offset:1024 lds
    v_mfma_f32_16x16x32_bf16 v[72:75], a[232:235], a[252:255], v[72:75]
    buffer_load_dwordx4 v18, s[48:51], s96 offen offset:2048 lds
    v_mfma_f32_16x16x32_bf16 v[76:79], a[236:239], a[248:251], v[76:79]
    buffer_load_dwordx4 v19, s[48:51], s96 offen offset:3072 lds
    v_mfma_f32_16x16x32_bf16 v[80:83], a[236:239], a[252:255], v[80:83]
    s_add_u32 m0, s99, 20480
    s_add_u32 s96, s96, 128
    buffer_load_dwordx4 v20, s[60:63], s97 offen lds
    s_waitcnt lgkmcnt(10)
    v_mfma_f32_16x16x32_bf16 v[36:39], a[192:195], a[240:243], v[36:39]
    ds_read_b128 a[248:251], v29 offset:0
    ds_read_b128 a[252:255], v29 offset:2048
    v_mfma_f32_16x16x32_bf16 v[40:43], a[192:195], a[244:247], v[40:43]
    ds_read_b64_tr_b16 a[216:217], v30 offset:6144
    ds_read_b64_tr_b16 a[218:219], v30 offset:6912
    s_waitcnt lgkmcnt(12)
    v_mfma_f32_16x16x32_bf16 v[44:47], a[196:199], a[240:243], v[44:47]
    ds_read_b64_tr_b16 a[220:221], v30 offset:6176
    ds_read_b64_tr_b16 a[222:223], v30 offset:6944
    v_mfma_f32_16x16x32_bf16 v[48:51], a[196:199], a[244:247], v[48:51]
    ds_read_b64_tr_b16 a[224:225], v30 offset:6208
    ds_read_b64_tr_b16 a[226:227], v30 offset:6976
    s_waitcnt lgkmcnt(14)
    v_mfma_f32_16x16x32_bf16 v[52:55], a[200:203], a[240:243], v[52:55]
    ds_read_b64_tr_b16 a[228:229], v30 offset:6240
    ds_read_b64_tr_b16 a[230:231], v30 offset:7008
    v_mfma_f32_16x16x32_bf16 v[56:59], a[200:203], a[244:247], v[56:59]
    ds_read_b64_tr_b16 a[232:233], v30 offset:6272
    ds_read_b64_tr_b16 a[234:235], v30 offset:7040
    s_waitcnt lgkmcnt(15)
    v_mfma_f32_16x16x32_bf16 v[60:63], a[204:207], a[240:243], v[60:63]
    ds_read_b64_tr_b16 a[236:237], v31 offset:6304
    ds_read_b64_tr_b16 a[238:239], v31 offset:7072
    v_mfma_f32_16x16x32_bf16 v[64:67], a[204:207], a[244:247], v[64:67]
    buffer_load_dwordx4 v21, s[60:63], s97 offen offset:1024 lds
    s_waitcnt lgkmcnt(15)
    v_mfma_f32_16x16x32_bf16 v[68:71], a[208:211], a[240:243], v[68:71]
    buffer_load_dwordx4 v22, s[60:63], s97 offen offset:2048 lds
    s_add_u32 s97, s97, 196608
    s_cmp_eq_u32 s96, 1280
    s_cmov_b32 s96, 0
    s_cmov_b32 s97, 0
    v_mfma_f32_16x16x32_bf16 v[72:75], a[208:211], a[244:247], v[72:75]
    s_waitcnt lgkmcnt(14)
    v_mfma_f32_16x16x32_bf16 v[76:79], a[212:215], a[240:243], v[76:79]
    v_mfma_f32_16x16x32_bf16 v[80:83], a[212:215], a[244:247], v[80:83]
    s_waitcnt lgkmcnt(0)
    s_waitcnt vmcnt(9)
    s_barrier
    v_mfma_f32_16x16x32_bf16 v[36:39], a[216:219], a[248:251], v[36:39]
    ds_read_b128 a[240:243], v28 offset:28672
    ds_read_b128 a[244:247], v28 offset:30720
    v_mfma_f32_16x16x32_bf16 v[40:43], a[216:219], a[252:255], v[40:43]
    ds_read_b64_tr_b16 a[192:193], v30 offset:28672
    ds_read_b64_tr_b16 a[194:195], v30 offset:29440
    v_mfma_f32_16x16x32_bf16 v[44:47], a[220:223], a[248:251], v[44:47]
    ds_read_b64_tr_b16 a[196:197], v30 offset:28704
    ds_read_b64_tr_b16 a[198:199], v30 offset:29472
    v_mfma_f32_16x16x32_bf16 v[48:51], a[220:223], a[252:255], v[48:51]
    ds_read_b64_tr_b16 a[200:201], v30 offset:28736
    ds_read_b64_tr_b16 a[202:203], v30 offset:29504
    v_mfma_f32_16x16x32_bf16 v[52:55], a[224:227], a[248:251], v[52:55]
    ds_read_b64_tr_b16 a[204:205], v30 offset:28768
    ds_read_b64_tr_b16 a[206:207], v30 offset:29536
    v_mfma_f32_16x16x32_bf16 v[56:59], a[224:227], a[252:255], v[56:59]
    ds_read_b64_tr_b16 a[208:209], v30 offset:28800
    ds_read_b64_tr_b16 a[210:211], v30 offset:29568
    v_mfma_f32_16x16x32_bf16 v[60:63], a[228:231], a[248:251], v[60:63]
    ds_read_b64_tr_b16 a[212:213], v31 offset:28832
    ds_read_b64_tr_b16 a[214:215], v31 offset:29600
    v_mfma_f32_16x16x32_bf16 v[64:67], a[228:231], a[252:255], v[64:67]
    s_add_u32 m0, s98, 49152
    s_nop 0
    buffer_load_dwordx4 v16, s[48:51], s96 offen lds
    v_mfma_f32_16x16x32_bf16 v[68:71], a[232:235], a[248:251], v[68:71]
    buffer_load_dwordx4 v17, s[48:51], s96 offen offset:1024 lds
    v_mfma_f32_16x16x32_bf16 v[72:75], a[232:235], a[252:255], v[72:75]
    buffer_load_dwordx4 v18, s[48:51], s96 offen offset:2048 lds
    v_mfma_f32_16x16x32_bf16 v[76:79], a[236:239], a[248:251], v[76:79]
    buffer_load_dwordx4 v19, s[48:51], s96 offen offset:3072 lds
    v_mfma_f32_16x16x32_bf16 v[80:83], a[236:239], a[252:255], v[80:83]
    s_add_u32 m0, s99, 49152
    s_add_u32 s96, s96, 128
    buffer_load_dwordx4 v20, s[60:63], s97 offen lds
    s_waitcnt vmcnt(26)
    s_mov_b32 s14, 20000
L_tok_7:
    v_readfirstlane_b32 s10, v244
    v_readfirstlane_b32 s11, v245
    s_cmp_lg_u32 s10, 0
    s_cbranch_scc1 L_tokok_8
    s_sub_u32 s14, s14, 1
    s_cmp_eq_u32 s14, 0
    s_cbranch_scc1 L_tokok_8
    s_sleep 2
    global_load_dwordx2 v[244:245], v248, s[42:43] sc1
    s_waitcnt vmcnt(0)
    s_branch L_tok_7
L_tokok_8:
    s_cmp_lg_u32 s9, 0
    s_cbranch_scc1 L_fs_9
    s_lshl_b32 s12, s6, 12
    s_add_u32 s12, s12, 0xf00000
    s_lshl_b32 s13, s5, 7
    s_add_u32 s12, s12, s13
    v_mov_b32 v244, s10
    v_mov_b32 v245, s11
    v_mov_b32 v243, s12
    s_mov_b64 exec, 1
    buffer_store_dwordx2 v[244:245], v243, s[68:71], 0 offen sc1
    s_mov_b64 exec, -1
L_fs_9:
    s_waitcnt lgkmcnt(10)
    v_mfma_f32_16x16x32_bf16 v[36:39], a[192:195], a[240:243], v[36:39]
    ds_read_b128 a[248:251], v29 offset:28672
    ds_read_b128 a[252:255], v29 offset:30720
    v_mfma_f32_16x16x32_bf16 v[40:43], a[192:195], a[244:247], v[40:43]
    ds_read_b64_tr_b16 a[216:217], v30 offset:34816
    ds_read_b64_tr_b16 a[218:219], v30 offset:35584
    s_waitcnt lgkmcnt(12)
    v_mfma_f32_16x16x32_bf16 v[44:47], a[196:199], a[240:243], v[44:47]
    ds_read_b64_tr_b16 a[220:221], v30 offset:34848
    ds_read_b64_tr_b16 a[222:223], v30 offset:35616
    v_mfma_f32_16x16x32_bf16 v[48:51], a[196:199], a[244:247], v[48:51]
    ds_read_b64_tr_b16 a[224:225], v30 offset:34880
    ds_read_b64_tr_b16 a[226:227], v30 offset:35648
    s_waitcnt lgkmcnt(14)
    v_mfma_f32_16x16x32_bf16 v[52:55], a[200:203], a[240:243], v[52:55]
    ds_read_b64_tr_b16 a[228:229], v30 offset:34912
    ds_read_b64_tr_b16 a[230:231], v30 offset:35680
    v_mfma_f32_16x16x32_bf16 v[56:59], a[200:203], a[244:247], v[56:59]
    ds_read_b64_tr_b16 a[232:233], v30 offset:34944
    ds_read_b64_tr_b16 a[234:235], v30 offset:35712
    s_waitcnt lgkmcnt(15)
    v_mfma_f32_16x16x32_bf16 v[60:63], a[204:207], a[240:243], v[60:63]
    ds_read_b64_tr_b16 a[236:237], v31 offset:34976
    ds_read_b64_tr_b16 a[238:239], v31 offset:35744
    v_mfma_f32_16x16x32_bf16 v[64:67], a[204:207], a[244:247], v[64:67]
    buffer_load_dwordx4 v21, s[60:63], s97 offen offset:1024 lds
    s_waitcnt lgkmcnt(15)
    v_mfma_f32_16x16x32_bf16 v[68:71], a[208:211], a[240:243], v[68:71]
    buffer_load_dwordx4 v22, s[60:63], s97 offen offset:2048 lds
    s_add_u32 s97, s97, 196608
    s_cmp_eq_u32 s96, 1280
    s_cmov_b32 s96, 0
    s_cmov_b32 s97, 0
    v_mfma_f32_16x16x32_bf16 v[72:75], a[208:211], a[244:247], v[72:75]
    s_waitcnt lgkmcnt(14)
    v_mfma_f32_16x16x32_bf16 v[76:79], a[212:215], a[240:243], v[76:79]
    v_mfma_f32_16x16x32_bf16 v[80:83], a[212:215], a[244:247], v[80:83]
    v_lshlrev_b32 v2, 4, v0
    v_subrev_u32 v3, 8, v2
    s_mov_b32 s78, 4096
    s_mov_b32 s79, 0x20000
    s_lshl_b32 s80, s90, 12
    s_add_u32 s76, s24, s80
    s_addc_u32 s77, s25, 0
    s_and_b32 s77, s77, 0xffff
    buffer_load_dwordx4 v[222:225], v2, s[76:79], 0 offen nt
    buffer_load_dwordx2 v[220:221], v3, s[76:79], 0 offen nt
    s_lshl_b32 s80, s91, 12
    s_add_u32 s76, s24, s80
    s_addc_u32 s77, s25, 0
    s_and_b32 s77, s77, 0xffff
    buffer_load_dwordx4 v[228:231], v2, s[76:79], 0 offen nt
    buffer_load_dwordx2 v[226:227], v3, s[76:79], 0 offen nt
    s_lshl_b32 s80, s92, 12
    s_add_u32 s76, s24, s80
    s_addc_u32 s77, s25, 0
    s_and_b32 s77, s77, 0xffff
    buffer_load_dwordx4 v[234:237], v2, s[76:79], 0 offen nt
    buffer_load_dwordx2 v[232:233], v3, s[76:79], 0 offen nt
    s_waitcnt lgkmcnt(0)
    s_waitcnt vmcnt(20)
    s_barrier
    v_mfma_f32_16x16x32_bf16 v[36:39], a[216:219], a[248:251], v[36:39]
    ds_read_b128 a[240:243], v32 offset:0
    ds_read_b128 a[244:247], v32 offset:2048
    v_mfma_f32_16x16x32_bf16 v[40:43], a[216:219], a[252:255], v[40:43]
    ds_read_b64_tr_b16 a[192:193], v34 offset:0
    ds_read_b64_tr_b16 a[194:195], v34 offset:768
    v_mfma_f32_16x16x32_bf16 v[44:47], a[220:223], a[248:251], v[44:47]
    ds_read_b64_tr_b16 a[196:197], v34 offset:32
    ds_read_b64_tr_b16 a[198:199], v34 offset:800
    v_mfma_f32_16x16x32_bf16 v[48:51], a[220:223], a[252:255], v[48:51]
    ds_read_b64_tr_b16 a[200:201], v34 offset:64
    ds_read_b64_tr_b16 a[202:203], v34 offset:832
    v_mfma_f32_16x16x32_bf16 v[52:55], a[224:227], a[248:251], v[52:55]
    ds_read_b64_tr_b16 a[204:205], v34 offset:96
    ds_read_b64_tr_b16 a[206:207], v34 offset:864
    v_mfma_f32_16x16x32_bf16 v[56:59], a[224:227], a[252:255], v[56:59]
    ds_read_b64_tr_b16 a[208:209], v34 offset:128
    ds_read_b64_tr_b16 a[210:211], v34 offset:896
    v_mfma_f32_16x16x32_bf16 v[60:63], a[228:231], a[248:251], v[60:63]
    ds_read_b64_tr_b16 a[212:213], v35 offset:160
    ds_read_b64_tr_b16 a[214:215], v35 offset:928
    v_mfma_f32_16x16x32_bf16 v[64:67], a[228:231], a[252:255], v[64:67]
    s_add_u32 m0, s98, 77824
    s_nop 0
    buffer_load_dwordx4 v16, s[48:51], s96 offen lds
    v_mfma_f32_16x16x32_bf16 v[68:71], a[232:235], a[248:251], v[68:71]
    buffer_load_dwordx4 v17, s[48:51], s96 offen offset:1024 lds
    v_mfma_f32_16x16x32_bf16 v[72:75], a[232:235], a[252:255], v[72:75]
    buffer_load_dwordx4 v18, s[48:51], s96 offen offset:2048 lds
    v_mfma_f32_16x16x32_bf16 v[76:79], a[236:239], a[248:251], v[76:79]
    buffer_load_dwordx4 v19, s[48:51], s96 offen offset:3072 lds
    v_mfma_f32_16x16x32_bf16 v[80:83], a[236:239], a[252:255], v[80:83]
    s_add_u32 m0, s99, 77824
    s_add_u32 s96, s96, 128
    buffer_load_dwordx4 v20, s[60:63], s97 offen lds
    s_waitcnt lgkmcnt(10)
    v_mfma_f32_16x16x32_bf16 v[36:39], a[192:195], a[240:243], v[36:39]
    ds_read_b128 a[248:251], v33 offset:0
    ds_read_b128 a[252:255], v33 offset:2048
    v_mfma_f32_16x16x32_bf16 v[40:43], a[192:195], a[244:247], v[40:43]
    ds_read_b64_tr_b16 a[216:217], v34 offset:6144
    ds_read_b64_tr_b16 a[218:219], v34 offset:6912
    s_waitcnt lgkmcnt(12)
    v_mfma_f32_16x16x32_bf16 v[44:47], a[196:199], a[240:243], v[44:47]
    ds_read_b64_tr_b16 a[220:221], v34 offset:6176
    ds_read_b64_tr_b16 a[222:223], v34 offset:6944
    v_mfma_f32_16x16x32_bf16 v[48:51], a[196:199], a[244:247], v[48:51]
    ds_read_b64_tr_b16 a[224:225], v34 offset:6208
    ds_read_b64_tr_b16 a[226:227], v34 offset:6976
    s_waitcnt lgkmcnt(14)
    v_mfma_f32_16x16x32_bf16 v[52:55], a[200:203], a[240:243], v[52:55]
    ds_read_b64_tr_b16 a[228:229], v34 offset:6240
    ds_read_b64_tr_b16 a[230:231], v34 offset:7008
    v_mfma_f32_16x16x32_bf16 v[56:59], a[200:203], a[244:247], v[56:59]
    ds_read_b64_tr_b16 a[232:233], v34 offset:6272
    ds_read_b64_tr_b16 a[234:235], v34 offset:7040
    s_waitcnt lgkmcnt(15)
    v_mfma_f32_16x16x32_bf16 v[60:63], a[204:207], a[240:243], v[60:63]
    ds_read_b64_tr_b16 a[236:237], v35 offset:6304
    ds_read_b64_tr_b16 a[238:239], v35 offset:7072
    v_mfma_f32_16x16x32_bf16 v[64:67], a[204:207], a[244:247], v[64:67]
    buffer_load_dwordx4 v21, s[60:63], s97 offen offset:1024 lds
    s_waitcnt lgkmcnt(15)
    v_mfma_f32_16x16x32_bf16 v[68:71], a[208:211], a[240:243], v[68:71]
    buffer_load_dwordx4 v22, s[60:63], s97 offen offset:2048 lds
    s_add_u32 s97, s97, 196608
    s_cmp_eq_u32 s96, 1280
    s_cmov_b32 s96, 0
    s_cmov_b32 s97, 0
    v_mfma_f32_16x16x32_bf16 v[72:75], a[208:211], a[244:247], v[72:75]
    s_waitcnt lgkmcnt(14)
    v_mfma_f32_16x16x32_bf16 v[76:79], a[212:215], a[240:243], v[76:79]
    v_mfma_f32_16x16x32_bf16 v[80:83], a[212:215], a[244:247], v[80:83]
    s_waitcnt lgkmcnt(0)
    s_waitcnt vmcnt(20)
    s_barrier
    v_mfma_f32_16x16x32_bf16 v[36:39], a[216:219], a[248:251], v[36:39]
    ds_read_b128 a[240:243], v24 offset:0
    ds_read_b128 a[244:247], v24 offset:2048
    v_mfma_f32_16x16x32_bf16 v[40:43], a[216:219], a[252:255], v[40:43]
    ds_read_b64_tr_b16 a[192:193], v26 offset:0
    ds_read_b64_tr_b16 a[194:195], v26 offset:768
    v_mfma_f32_16x16x32_bf16 v[44:47], a[220:223], a[248:251], v[44:47]
    ds_read_b64_tr_b16 a[196:197], v26 offset:32
    ds_read_b64_tr_b16 a[198:199], v26 offset:800
    v_mfma_f32_16x16x32_bf16 v[48:51], a[220:223], a[252:255], v[48:51]
    ds_read_b64_tr_b16 a[200:201], v26 offset:64
    ds_read_b64_tr_b16 a[202:203], v26 offset:832
    v_mfma_f32_16x16x32_bf16 v[52:55], a[224:227], a[248:251], v[52:55]
    ds_read_b64_tr_b16 a[204:205], v26 offset:96
    ds_read_b64_tr_b16 a[206:207], v26 offset:864
    v_mfma_f32_16x16x32_bf16 v[56:59], a[224:227], a[252:255], v[56:59]
    ds_read_b64_tr_b16 a[208:209], v26 offset:128
    ds_read_b64_tr_b16 a[210:211], v26 offset:896
    v_mfma_f32_16x16x32_bf16 v[60:63], a[228:231], a[248:251], v[60:63]
    ds_read_b64_tr_b16 a[212:213], v27 offset:160
    ds_read_b64_tr_b16 a[214:215], v27 offset:928
    v_mfma_f32_16x16x32_bf16 v[64:67], a[228:231], a[252:255], v[64:67]
    s_add_u32 m0, s98, 106496
    s_nop 0
    buffer_load_dwordx4 v16, s[48:51], s96 offen lds
    v_mfma_f32_16x16x32_bf16 v[68:71], a[232:235], a[248:251], v[68:71]
    buffer_load_dwordx4 v17, s[48:51], s96 offen offset:1024 lds
    v_mfma_f32_16x16x32_bf16 v[72:75], a[232:235], a[252:255], v[72:75]
    buffer_load_dwordx4 v18, s[48:51], s96 offen offset:2048 lds
    v_mfma_f32_16x16x32_bf16 v[76:79], a[236:239], a[248:251], v[76:79]
    buffer_load_dwordx4 v19, s[48:51], s96 offen offset:3072 lds
    v_mfma_f32_16x16x32_bf16 v[80:83], a[236:239], a[252:255], v[80:83]
    s_add_u32 m0, s99, 106496
    s_add_u32 s96, s96, 128
    buffer_load_dwordx4 v20, s[60:63], s97 offen lds
    s_waitcnt lgkmcnt(10)
    v_mfma_f32_16x16x32_bf16 v[36:39], a[192:195], a[240:243], v[36:39]
    ds_read_b128 a[248:251], v25 offset:0
    ds_read_b128 a[252:255], v25 offset:2048
    v_mfma_f32_16x16x32_bf16 v[40:43], a[192:195], a[244:247], v[40:43]
    ds_read_b64_tr_b16 a[216:217], v26 offset:6144
    ds_read_b64_tr_b16 a[218:219], v26 offset:6912
    s_waitcnt lgkmcnt(12)
    v_mfma_f32_16x16x32_bf16 v[44:47], a[196:199], a[240:243], v[44:47]
    ds_read_b64_tr_b16 a[220:221], v26 offset:6176
    ds_read_b64_tr_b16 a[222:223], v26 offset:6944
    v_mfma_f32_16x16x32_bf16 v[48:51], a[196:199], a[244:247], v[48:51]
    ds_read_b64_tr_b16 a[224:225], v26 offset:6208
    ds_read_b64_tr_b16 a[226:227], v26 offset:6976
    s_waitcnt lgkmcnt(14)
    v_mfma_f32_16x16x32_bf16 v[52:55], a[200:203], a[240:243], v[52:55]
    ds_read_b64_tr_b16 a[228:229], v26 offset:6240
    ds_read_b64_tr_b16 a[230:231], v26 offset:7008
    v_mfma_f32_16x16x32_bf16 v[56:59], a[200:203], a[244:247], v[56:59]
    ds_read_b64_tr_b16 a[232:233], v26 offset:6272
    ds_read_b64_tr_b16 a[234:235], v26 offset:7040
    s_waitcnt lgkmcnt(15)
    v_mfma_f32_16x16x32_bf16 v[60:63], a[204:207], a[240:243], v[60:63]
    ds_read_b64_tr_b16 a[236:237], v27 offset:6304
    ds_read_b64_tr_b16 a[238:239], v27 offset:7072
    v_mfma_f32_16x16x32_bf16 v[64:67], a[204:207], a[244:247], v[64:67]
    buffer_load_dwordx4 v21, s[60:63], s97 offen offset:1024 lds
    s_waitcnt lgkmcnt(15)
    v_mfma_f32_16x16x32_bf16 v[68:71], a[208:211], a[240:243], v[68:71]
    buffer_load_dwordx4 v22, s[60:63], s97 offen offset:2048 lds
    s_add_u32 s97, s97, 196608
    s_cmp_eq_u32 s96, 1280
    s_cmov_b32 s96, 0
    s_cmov_b32 s97, 0
    v_mfma_f32_16x16x32_bf16 v[72:75], a[208:211], a[244:247], v[72:75]
    s_waitcnt lgkmcnt(14)
    v_mfma_f32_16x16x32_bf16 v[76:79], a[212:215], a[240:243], v[76:79]
    v_mfma_f32_16x16x32_bf16 v[80:83], a[212:215], a[244:247], v[80:83]
    v_lshrrev_b32 v14, 5, v1
    v_and_b32 v15, 31, v1
    s_lshl_b32 s80, s7, 7
    s_lshl_b32 s81, s8, 3
    s_add_u32 s80, s80, s81
    s_lshl_b32 s81, s9, 1
    s_add_u32 s80, s80, s81
    v_add_u32 v14, s80, v14
    v_mul_u32_u24 v4, 1280, v14
    v_lshlrev_b32 v5, 3, v15
    v_add_u32 v4, v4, v5
    buffer_load_dwordx2 v[100:101], v4, s[48:51], 0 offen offset:0
    global_load_dwordx2 v[110:111], v5, s[38:39] offset:0
    buffer_load_dwordx2 v[102:103], v4, s[48:51], 0 offen offset:256
    global_load_dwordx2 v[112:113], v5, s[38:39] offset:256
    buffer_load_dwordx2 v[104:105], v4, s[48:51], 0 offen offset:512
    global_load_dwordx2 v[114:115], v5, s[38:39] offset:512
    buffer_load_dwordx2 v[106:107], v4, s[48:51], 0 offen offset:768
    global_load_dwordx2 v[116:117], v5, s[38:39] offset:768
    buffer_load_dwordx2 v[108:109], v4, s[48:51], 0 offen offset:1024
    global_load_dwordx2 v[118:119], v5, s[38:39] offset:1024
    s_waitcnt lgkmcnt(0)
    s_waitcnt vmcnt(30)
    s_barrier
    v_mfma_f32_16x16x32_bf16 v[36:39], a[216:219], a[248:251], v[36:39]
    ds_read_b128 a[240:243], v24 offset:28672
    ds_read_b128 a[244:247], v24 offset:30720
    v_mfma_f32_16x16x32_bf16 v[40:43], a[216:219], a[252:255], v[40:43]
    ds_read_b64_tr_b16 a[192:193], v26 offset:28672
    ds_read_b64_tr_b16 a[194:195], v26 offset:29440
    v_mfma_f32_16x16x32_bf16 v[44:47], a[220:223], a[248:251], v[44:47]
    ds_read_b64_tr_b16 a[196:197], v26 offset:28704
    ds_read_b64_tr_b16 a[198:199], v26 offset:29472
    v_mfma_f32_16x16x32_bf16 v[48:51], a[220:223], a[252:255], v[48:51]
    ds_read_b64_tr_b16 a[200:201], v26 offset:28736
    ds_read_b64_tr_b16 a[202:203], v26 offset:29504
    v_mfma_f32_16x16x32_bf16 v[52:55], a[224:227], a[248:251], v[52:55]
    ds_read_b64_tr_b16 a[204:205], v26 offset:28768
    ds_read_b64_tr_b16 a[206:207], v26 offset:29536
    v_mfma_f32_16x16x32_bf16 v[56:59], a[224:227], a[252:255], v[56:59]
    ds_read_b64_tr_b16 a[208:209], v26 offset:28800
    ds_read_b64_tr_b16 a[210:211], v26 offset:29568
    v_mfma_f32_16x16x32_bf16 v[60:63], a[228:231], a[248:251], v[60:63]
    ds_read_b64_tr_b16 a[212:213], v27 offset:28832
    ds_read_b64_tr_b16 a[214:215], v27 offset:29600
    v_mfma_f32_16x16x32_bf16 v[64:67], a[228:231], a[252:255], v[64:67]
    s_add_u32 m0, s98, 135168
    s_nop 0
    buffer_load_dwordx4 v16, s[48:51], s96 offen lds
    v_mfma_f32_16x16x32_bf16 v[68:71], a[232:235], a[248:251], v[68:71]
    buffer_load_dwordx4 v17, s[48:51], s96 offen offset:1024 lds
    v_mfma_f32_16x16x32_bf16 v[72:75], a[232:235], a[252:255], v[72:75]
    buffer_load_dwordx4 v18, s[48:51], s96 offen offset:2048 lds
    v_mfma_f32_16x16x32_bf16 v[76:79], a[236:239], a[248:251], v[76:79]
    buffer_load_dwordx4 v19, s[48:51], s96 offen offset:3072 lds
    v_mfma_f32_16x16x32_bf16 v[80:83], a[236:239], a[252:255], v[80:83]
    s_add_u32 m0, s99, 135168
    s_add_u32 s96, s96, 128
    buffer_load_dwordx4 v20, s[60:63], s97 offen lds
    s_waitcnt lgkmcnt(10)
    v_mfma_f32_16x16x32_bf16 v[36:39], a[192:195], a[240:243], v[36:39]
    ds_read_b128 a[248:251], v25 offset:28672
    ds_read_b128 a[252:255], v25 offset:30720
    v_mfma_f32_16x16x32_bf16 v[40:43], a[192:195], a[244:247], v[40:43]
    ds_read_b64_tr_b16 a[216:217], v26 offset:34816
    ds_read_b64_tr_b16 a[218:219], v26 offset:35584
    s_waitcnt lgkmcnt(12)
    v_mfma_f32_16x16x32_bf16 v[44:47], a[196:199], a[240:243], v[44:47]
    ds_read_b64_tr_b16 a[220:221], v26 offset:34848
    ds_read_b64_tr_b16 a[222:223], v26 offset:35616
    v_mfma_f32_16x16x32_bf16 v[48:51], a[196:199], a[244:247], v[48:51]
    ds_read_b64_tr_b16 a[224:225], v26 offset:34880
    ds_read_b64_tr_b16 a[226:227], v26 offset:35648
    s_waitcnt lgkmcnt(14)
    v_mfma_f32_16x16x32_bf16 v[52:55], a[200:203], a[240:243], v[52:55]
    ds_read_b64_tr_b16 a[228:229], v26 offset:34912
    ds_read_b64_tr_b16 a[230:231], v26 offset:35680
    v_mfma_f32_16x16x32_bf16 v[56:59], a[200:203], a[244:247], v[56:59]
    ds_read_b64_tr_b16 a[232:233], v26 offset:34944
    ds_read_b64_tr_b16 a[234:235], v26 offset:35712
    s_waitcnt lgkmcnt(15)
    v_mfma_f32_16x16x32_bf16 v[60:63], a[204:207], a[240:243], v[60:63]
    ds_read_b64_tr_b16 a[236:237], v27 offset:34976
    ds_read_b64_tr_b16 a[238:239], v27 offset:35744
    v_mfma_f32_16x16x32_bf16 v[64:67], a[204:207], a[244:247], v[64:67]
    buffer_load_dwordx4 v21, s[60:63], s97 offen offset:1024 lds
    s_waitcnt lgkmcnt(15)
    v_mfma_f32_16x16x32_bf16 v[68:71], a[208:211], a[240:243], v[68:71]
    buffer_load_dwordx4 v22, s[60:63], s97 offen offset:2048 lds
    s_add_u32 s97, s97, 196608
    s_cmp_eq_u32 s96, 1280
    s_cmov_b32 s96, 0
    s_cmov_b32 s97, 0
    v_mfma_f32_16x16x32_bf16 v[72:75], a[208:211], a[244:247], v[72:75]
    s_waitcnt lgkmcnt(14)
    v_mfma_f32_16x16x32_bf16 v[76:79], a[212:215], a[240:243], v[76:79]
    v_mfma_f32_16x16x32_bf16 v[80:83], a[212:215], a[244:247], v[80:83]
    s_lshl_b32 s12, s6, 12
    s_add_u32 s12, s12, 0xf00000
    v_and_b32 v248, 31, v1
    v_lshlrev_b32 v248, 7, v248
    v_add_u32 v248, s12, v248
    buffer_load_dwordx2 v[246:247], v248, s[68:71], 0 offen sc1
    s_waitcnt lgkmcnt(0)
    s_waitcnt vmcnt(25)
    s_barrier
    v_mfma_f32_16x16x32_bf16 v[36:39], a[216:219], a[248:251], v[36:39]
    ds_read_b128 a[240:243], v28 offset:0
    ds_read_b128 a[244:247], v28 offset:2048
    v_mfma_f32_16x16x32_bf16 v[40:43], a[216:219], a[252:255], v[40:43]
    ds_read_b64_tr_b16 a[192:193], v30 offset:0
    ds_read_b64_tr_b16 a[194:195], v30 offset:768
    v_mfma_f32_16x16x32_bf16 v[44:47], a[220:223], a[248:251], v[44:47]
    ds_read_b64_tr_b16 a[196:197], v30 offset:32
    ds_read_b64_tr_b16 a[198:199], v30 offset:800
    v_mfma_f32_16x16x32_bf16 v[48:51], a[220:223], a[252:255], v[48:51]
    ds_read_b64_tr_b16 a[200:201], v30 offset:64
    ds_read_b64_tr_b16 a[202:203], v30 offset:832
    v_mfma_f32_16x16x32_bf16 v[52:55], a[224:227], a[248:251], v[52:55]
    ds_read_b64_tr_b16 a[204:205], v30 offset:96
    ds_read_b64_tr_b16 a[206:207], v30 offset:864
    v_mfma_f32_16x16x32_bf16 v[56:59], a[224:227], a[252:255], v[56:59]
    ds_read_b64_tr_b16 a[208:209], v30 offset:128
    ds_read_b64_tr_b16 a[210:211], v30 offset:896
    v_mfma_f32_16x16x32_bf16 v[60:63], a[228:231], a[248:251], v[60:63]
    ds_read_b64_tr_b16 a[212:213], v31 offset:160
    ds_read_b64_tr_b16 a[214:215], v31 offset:928
    v_mfma_f32_16x16x32_bf16 v[64:67], a[228:231], a[252:255], v[64:67]
    v_mfma_f32_16x16x32_bf16 v[68:71], a[232:235], a[248:251], v[68:71]
    v_mfma_f32_16x16x32_bf16 v[72:75], a[232:235], a[252:255], v[72:75]
    v_mfma_f32_16x16x32_bf16 v[76:79], a[236:239], a[248:251], v[76:79]
    v_mfma_f32_16x16x32_bf16 v[80:83], a[236:239], a[252:255], v[80:83]
    s_waitcnt lgkmcnt(10)
    v_mfma_f32_16x16x32_bf16 v[36:39], a[192:195], a[240:243], v[36:39]
    ds_read_b128 a[248:251], v29 offset:0
    ds_read_b128 a[252:255], v29 offset:2048
    v_mfma_f32_16x16x32_bf16 v[40:43], a[192:195], a[244:247], v[40:43]
    ds_read_b64_tr_b16 a[216:217], v30 offset:6144
    ds_read_b64_tr_b16 a[218:219], v30 offset:6912
    s_waitcnt lgkmcnt(12)
    v_mfma_f32_16x16x32_bf16 v[44:47], a[196:199], a[240:243], v[44:47]
    ds_read_b64_tr_b16 a[220:221], v30 offset:6176
    ds_read_b64_tr_b16 a[222:223], v30 offset:6944
    v_mfma_f32_16x16x32_bf16 v[48:51], a[196:199], a[244:247], v[48:51]
    ds_read_b64_tr_b16 a[224:225], v30 offset:6208
    ds_read_b64_tr_b16 a[226:227], v30 offset:6976
    s_waitcnt lgkmcnt(14)
    v_mfma_f32_16x16x32_bf16 v[52:55], a[200:203], a[240:243], v[52:55]
    ds_read_b64_tr_b16 a[228:229], v30 offset:6240
    ds_read_b64_tr_b16 a[230:231], v30 offset:7008
    v_mfma_f32_16x16x32_bf16 v[56:59], a[200:203], a[244:247], v[56:59]
    ds_read_b64_tr_b16 a[232:233], v30 offset:6272
    ds_read_b64_tr_b16 a[234:235], v30 offset:7040
    s_waitcnt lgkmcnt(15)
    v_mfma_f32_16x16x32_bf16 v[60:63], a[204:207], a[240:243], v[60:63]
    ds_read_b64_tr_b16 a[236:237], v31 offset:6304
    ds_read_b64_tr_b16 a[238:239], v31 offset:7072
    v_mfma_f32_16x16x32_bf16 v[64:67], a[204:207], a[244:247], v[64:67]
    s_waitcnt lgkmcnt(15)
    v_mfma_f32_16x16x32_bf16 v[68:71], a[208:211], a[240:243], v[68:71]
    v_mfma_f32_16x16x32_bf16 v[72:75], a[208:211], a[244:247], v[72:75]
    s_waitcnt lgkmcnt(14)
    v_mfma_f32_16x16x32_bf16 v[76:79], a[212:215], a[240:243], v[76:79]
    v_mfma_f32_16x16x32_bf16 v[80:83], a[212:215], a[244:247], v[80:83]
    s_waitcnt vmcnt(8)
    v_mov_b32 v10, 0
    v_mov_b32 v11, 0
    v_dot2_f32_bf16 v10, v100, v110, v10
    v_dot2_f32_bf16 v11, v101, v111, v11
    v_dot2_f32_bf16 v10, v102, v112, v10
    v_dot2_f32_bf16 v11, v103, v113, v11
    v_dot2_f32_bf16 v10, v104, v114, v10
    v_dot2_f32_bf16 v11, v105, v115, v11
    v_dot2_f32_bf16 v10, v106, v116, v10
    v_dot2_f32_bf16 v11, v107, v117, v11
    v_dot2_f32_bf16 v10, v108, v118, v10
    v_dot2_f32_bf16 v11, v109, v119, v11
    s_nop 3
    v_add_f32 v10, v10, v11
    s_nop 1
    v_add_f32_dpp v10, v10, v10 quad_perm:[1,0,3,2] row_mask:0xf bank_mask:0xf
    s_nop 1
    v_add_f32_dpp v10, v10, v10 quad_perm:[2,3,0,1] row_mask:0xf bank_mask:0xf
    s_nop 1
    v_add_f32_dpp v10, v10, v10 row_half_mirror row_mask:0xf bank_mask:0xf
    s_nop 1
    v_add_f32_dpp v10, v10, v10 row_mirror row_mask:0xf bank_mask:0xf
    s_nop 1
    v_add_f32_dpp v10, v10, v10 row_bcast:15 row_mask:0xa bank_mask:0xf
    v_cvt_pk_bf16_f32 v10, v10, v10
    v_lshlrev_b32 v10, 16, v10
    v_mul_f32 v10, 0xbfb8aa3b, v10
    v_exp_f32 v10, v10
    s_nop 0
    v_add_f32 v10, 1.0, v10
    v_rcp_f32 v10, v10
    s_nop 0
    v_cvt_pk_bf16_f32 v10, v10, v10
    v_lshlrev_b32 v10, 16, v10
    v_lshlrev_b32 v4, 2, v14
    v_add_u32 v4, 0xe00000, v4
    v_cmp_eq_u32 vcc, 31, v15
    s_nop 0
    s_and_saveexec_b64 s[82:83], vcc
    buffer_store_dword v10, v4, s[68:71], 0 offen sc1
    s_mov_b64 exec, s[82:83]
    s_waitcnt lgkmcnt(0)
    s_waitcnt vmcnt(19)
    s_barrier
    v_mfma_f32_16x16x32_bf16 v[36:39], a[216:219], a[248:251], v[36:39]
    ds_read_b128 a[240:243], v28 offset:28672
    ds_read_b128 a[244:247], v28 offset:30720
    v_mfma_f32_16x16x32_bf16 v[40:43], a[216:219], a[252:255], v[40:43]
    ds_read_b64_tr_b16 a[192:193], v30 offset:28672
    ds_read_b64_tr_b16 a[194:195], v30 offset:29440
    v_mfma_f32_16x16x32_bf16 v[44:47], a[220:223], a[248:251], v[44:47]
    ds_read_b64_tr_b16 a[196:197], v30 offset:28704
    ds_read_b64_tr_b16 a[198:199], v30 offset:29472
    v_mfma_f32_16x16x32_bf16 v[48:51], a[220:223], a[252:255], v[48:51]
    ds_read_b64_tr_b16 a[200:201], v30 offset:28736
    ds_read_b64_tr_b16 a[202:203], v30 offset:29504
    v_mfma_f32_16x16x32_bf16 v[52:55], a[224:227], a[248:251], v[52:55]
    ds_read_b64_tr_b16 a[204:205], v30 offset:28768
    ds_read_b64_tr_b16 a[206:207], v30 offset:29536
    v_mfma_f32_16x16x32_bf16 v[56:59], a[224:227], a[252:255], v[56:59]
    ds_read_b64_tr_b16 a[208:209], v30 offset:28800
    ds_read_b64_tr_b16 a[210:211], v30 offset:29568
    v_mfma_f32_16x16x32_bf16 v[60:63], a[228:231], a[248:251], v[60:63]
    ds_read_b64_tr_b16 a[212:213], v31 offset:28832
    ds_read_b64_tr_b16 a[214:215], v31 offset:29600
    v_mfma_f32_16x16x32_bf16 v[64:67], a[228:231], a[252:255], v[64:67]
    v_mfma_f32_16x16x32_bf16 v[68:71], a[232:235], a[248:251], v[68:71]
    v_mfma_f32_16x16x32_bf16 v[72:75], a[232:235], a[252:255], v[72:75]
    v_mfma_f32_16x16x32_bf16 v[76:79], a[236:239], a[248:251], v[76:79]
    v_mfma_f32_16x16x32_bf16 v[80:83], a[236:239], a[252:255], v[80:83]
    s_cmp_ge_u32 s9, 3
    s_cbranch_scc1 L_zf_10
    v_mov_b32 v8, 0
    v_mov_b32 v9, 0
    v_mov_b32 v10, 0
    v_mov_b32 v11, 0
    s_mul_i32 s80, s9, 25856
    v_lshlrev_b32 v2, 4, v1
    v_add_u32 v2, s80, v2
    v_bfe_u32 v3, v1, 2, 2
    v_mul_u32_u24 v3, 4160, v3
    v_and_b32 v4, 3, v1
    v_lshl_add_u32 v3, v4, 4, v3
    v_add_u32 v3, s80, v3
    v_cmp_gt_u32 vcc, 29, v1
    s_nop 0
    s_and_saveexec_b64 s[82:83], vcc
    ds_write_b128 v2, v[8:11] offset:20736
    ds_write_b128 v2, v[8:11] offset:25392
    ds_write_b128 v3, v[8:11] offset:0
    v_and_b32 v4, 3, v1
    v_lshlrev_b32 v4, 4, v4
    v_add_u32 v4, 77568, v4
    ds_write_b128 v4, v[8:11]
    s_mov_b64 exec, s[82:83]
L_zf_10:
    s_waitcnt lgkmcnt(10)
    v_mfma_f32_16x16x32_bf16 v[36:39], a[192:195], a[240:243], v[36:39]
    ds_read_b128 a[248:251], v29 offset:28672
    ds_read_b128 a[252:255], v29 offset:30720
    v_mfma_f32_16x16x32_bf16 v[40:43], a[192:195], a[244:247], v[40:43]
    ds_read_b64_tr_b16 a[216:217], v30 offset:34816
    ds_read_b64_tr_b16 a[218:219], v30 offset:35584
    s_waitcnt lgkmcnt(12)
    v_mfma_f32_16x16x32_bf16 v[44:47], a[196:199], a[240:243], v[44:47]
    ds_read_b64_tr_b16 a[220:221], v30 offset:34848
    ds_read_b64_tr_b16 a[222:223], v30 offset:35616
    v_mfma_f32_16x16x32_bf16 v[48:51], a[196:199], a[244:247], v[48:51]
    ds_read_b64_tr_b16 a[224:225], v30 offset:34880
    ds_read_b64_tr_b16 a[226:227], v30 offset:35648
    s_waitcnt lgkmcnt(14)
    v_mfma_f32_16x16x32_bf16 v[52:55], a[200:203], a[240:243], v[52:55]
    ds_read_b64_tr_b16 a[228:229], v30 offset:34912
    ds_read_b64_tr_b16 a[230:231], v30 offset:35680
    v_mfma_f32_16x16x32_bf16 v[56:59], a[200:203], a[244:247], v[56:59]
    ds_read_b64_tr_b16 a[232:233], v30 offset:34944
    ds_read_b64_tr_b16 a[234:235], v30 offset:35712
    s_waitcnt lgkmcnt(15)
    v_mfma_f32_16x16x32_bf16 v[60:63], a[204:207], a[240:243], v[60:63]
    ds_read_b64_tr_b16 a[236:237], v31 offset:34976
    ds_read_b64_tr_b16 a[238:239], v31 offset:35744
    v_mfma_f32_16x16x32_bf16 v[64:67], a[204:207], a[244:247], v[64:67]
    s_waitcnt lgkmcnt(15)
    v_mfma_f32_16x16x32_bf16 v[68:71], a[208:211], a[240:243], v[68:71]
    v_mfma_f32_16x16x32_bf16 v[72:75], a[208:211], a[244:247], v[72:75]
    s_waitcnt lgkmcnt(14)
    v_mfma_f32_16x16x32_bf16 v[76:79], a[212:215], a[240:243], v[76:79]
    v_mfma_f32_16x16x32_bf16 v[80:83], a[212:215], a[244:247], v[80:83]
    s_waitcnt vmcnt(1)
    s_mov_b32 s14, 20000
L_poll_11:
    v_cmp_eq_u64 vcc, s[10:11], v[246:247]
    s_nop 0
    s_cmp_eq_u64 vcc, -1
    s_cbranch_scc1 L_pollok_12
    s_sub_u32 s14, s14, 1
    s_cmp_eq_u32 s14, 0
    s_cbranch_scc1 L_pollok_12
    s_sleep 1
    buffer_load_dwordx2 v[246:247], v248, s[68:71], 0 offen sc1
    s_waitcnt vmcnt(0)
    s_branch L_poll_11
L_pollok_12:
    v_lshlrev_b32 v2, 4, v0
    s_lshl_b32 s80, s90, 12
    buffer_load_dwordx4 v[140:143], v2, s[68:71], s80 offen sc1
    s_lshl_b32 s81, s91, 12
    buffer_load_dwordx4 v[144:147], v2, s[68:71], s81 offen sc1
    s_lshl_b32 s82, s92, 12
    buffer_load_dwordx4 v[148:151], v2, s[68:71], s82 offen sc1
    s_waitcnt lgkmcnt(0)
    s_waitcnt vmcnt(5)
    s_barrier
    v_mfma_f32_16x16x32_bf16 v[36:39], a[216:219], a[248:251], v[36:39]
    ds_read_b128 a[240:243], v32 offset:0
    ds_read_b128 a[244:247], v32 offset:2048
    v_mfma_f32_16x16x32_bf16 v[40:43], a[216:219], a[252:255], v[40:43]
    ds_read_b64_tr_b16 a[192:193], v34 offset:0
    ds_read_b64_tr_b16 a[194:195], v34 offset:768
    v_mfma_f32_16x16x32_bf16 v[44:47], a[220:223], a[248:251], v[44:47]
    ds_read_b64_tr_b16 a[196:197], v34 offset:32
    ds_read_b64_tr_b16 a[198:199], v34 offset:800
    v_mfma_f32_16x16x32_bf16 v[48:51], a[220:223], a[252:255], v[48:51]
    ds_read_b64_tr_b16 a[200:201], v34 offset:64
    ds_read_b64_tr_b16 a[202:203], v34 offset:832
    v_mfma_f32_16x16x32_bf16 v[52:55], a[224:227], a[248:251], v[52:55]
    ds_read_b64_tr_b16 a[204:205], v34 offset:96
    ds_read_b64_tr_b16 a[206:207], v34 offset:864
    v_mfma_f32_16x16x32_bf16 v[56:59], a[224:227], a[252:255], v[56:59]
    ds_read_b64_tr_b16 a[208:209], v34 offset:128
    ds_read_b64_tr_b16 a[210:211], v34 offset:896
    v_mfma_f32_16x16x32_bf16 v[60:63], a[228:231], a[248:251], v[60:63]
    ds_read_b64_tr_b16 a[212:213], v35 offset:160
    ds_read_b64_tr_b16 a[214:215], v35 offset:928
    v_mfma_f32_16x16x32_bf16 v[64:67], a[228:231], a[252:255], v[64:67]
    v_lshlrev_b32 v242, 4, v1
    s_mul_i32 s101, s6, 48
    s_mul_i32 s100, s9, 12
    s_add_u32 s101, s101, s100
    s_mul_i32 s101, s101, 5120
    s_add_u32 s101, s101, 0xc00000
    buffer_load_dwordx4 a[0:3], v242, s[68:71], s101 offen offset:0 sc1
    v_mfma_f32_16x16x32_bf16 v[68:71], a[232:235], a[248:251], v[68:71]
    buffer_load_dwordx4 a[4:7], v242, s[68:71], s101 offen offset:1024 sc1
    v_mfma_f32_16x16x32_bf16 v[72:75], a[232:235], a[252:255], v[72:75]
    buffer_load_dwordx4 a[8:11], v242, s[68:71], s101 offen offset:2048 sc1
    v_mfma_f32_16x16x32_bf16 v[76:79], a[236:239], a[248:251], v[76:79]
    buffer_load_dwordx4 a[12:15], v242, s[68:71], s101 offen offset:3072 sc1
    s_add_u32 s101, s101, 4096
    v_mfma_f32_16x16x32_bf16 v[80:83], a[236:239], a[252:255], v[80:83]
    buffer_load_dwordx4 a[16:19], v242, s[68:71], s101 offen offset:0 sc1
    s_waitcnt lgkmcnt(10)
    v_mfma_f32_16x16x32_bf16 v[36:39], a[192:195], a[240:243], v[36:39]
    ds_read_b128 a[248:251], v33 offset:0
    ds_read_b128 a[252:255], v33 offset:2048
    v_mfma_f32_16x16x32_bf16 v[40:43], a[192:195], a[244:247], v[40:43]
    ds_read_b64_tr_b16 a[216:217], v34 offset:6144
    ds_read_b64_tr_b16 a[218:219], v34 offset:6912
    s_waitcnt lgkmcnt(12)
    v_mfma_f32_16x16x32_bf16 v[44:47], a[196:199], a[240:243], v[44:47]
    ds_read_b64_tr_b16 a[220:221], v34 offset:6176
    ds_read_b64_tr_b16 a[222:223], v34 offset:6944
    v_mfma_f32_16x16x32_bf16 v[48:51], a[196:199], a[244:247], v[48:51]
    ds_read_b64_tr_b16 a[224:225], v34 offset:6208
    ds_read_b64_tr_b16 a[226:227], v34 offset:6976
    s_waitcnt lgkmcnt(14)
    v_mfma_f32_16x16x32_bf16 v[52:55], a[200:203], a[240:243], v[52:55]
    ds_read_b64_tr_b16 a[228:229], v34 offset:6240
    ds_read_b64_tr_b16 a[230:231], v34 offset:7008
    v_mfma_f32_16x16x32_bf16 v[56:59], a[200:203], a[244:247], v[56:59]
    ds_read_b64_tr_b16 a[232:233], v34 offset:6272
    ds_read_b64_tr_b16 a[234:235], v34 offset:7040
    s_waitcnt lgkmcnt(15)
    v_mfma_f32_16x16x32_bf16 v[60:63], a[204:207], a[240:243], v[60:63]
    ds_read_b64_tr_b16 a[236:237], v35 offset:6304
    ds_read_b64_tr_b16 a[238:239], v35 offset:7072
    v_mfma_f32_16x16x32_bf16 v[64:67], a[204:207], a[244:247], v[64:67]
    buffer_load_dwordx4 a[20:23], v242, s[68:71], s101 offen offset:1024 sc1
    s_waitcnt lgkmcnt(15)
    v_mfma_f32_16x16x32_bf16 v[68:71], a[208:211], a[240:243], v[68:71]
    buffer_load_dwordx4 a[24:27], v242, s[68:71], s101 offen offset:2048 sc1
    v_mfma_f32_16x16x32_bf16 v[72:75], a[208:211], a[244:247], v[72:75]
    buffer_load_dwordx4 a[28:31], v242, s[68:71], s101 offen offset:3072 sc1
    s_add_u32 s101, s101, 4096
    s_waitcnt lgkmcnt(14)
    v_mfma_f32_16x16x32_bf16 v[76:79], a[212:215], a[240:243], v[76:79]
    v_mfma_f32_16x16x32_bf16 v[80:83], a[212:215], a[244:247], v[80:83]
    s_waitcnt lgkmcnt(10)
    v_mfma_f32_16x16x32_bf16 v[36:39], a[216:219], a[248:251], v[36:39]
    v_mfma_f32_16x16x32_bf16 v[40:43], a[216:219], a[252:255], v[40:43]
    s_waitcnt lgkmcnt(8)
    v_mfma_f32_16x16x32_bf16 v[44:47], a[220:223], a[248:251], v[44:47]
    v_mfma_f32_16x16x32_bf16 v[48:51], a[220:223], a[252:255], v[48:51]
    buffer_load_dwordx4 a[32:35], v242, s[68:71], s101 offen offset:0 sc1
    s_waitcnt lgkmcnt(6)
    v_mfma_f32_16x16x32_bf16 v[52:55], a[224:227], a[248:251], v[52:55]
    v_mfma_f32_16x16x32_bf16 v[56:59], a[224:227], a[252:255], v[56:59]
    s_waitcnt lgkmcnt(4)
    v_mfma_f32_16x16x32_bf16 v[60:63], a[228:231], a[248:251], v[60:63]
    v_mfma_f32_16x16x32_bf16 v[64:67], a[228:231], a[252:255], v[64:67]
    buffer_load_dwordx4 a[36:39], v242, s[68:71], s101 offen offset:1024 sc1
    s_waitcnt lgkmcnt(2)
    v_mfma_f32_16x16x32_bf16 v[68:71], a[232:235], a[248:251], v[68:71]
    v_mfma_f32_16x16x32_bf16 v[72:75], a[232:235], a[252:255], v[72:75]
    s_waitcnt lgkmcnt(0)
    v_mfma_f32_16x16x32_bf16 v[76:79], a[236:239], a[248:251], v[76:79]
    v_mfma_f32_16x16x32_bf16 v[80:83], a[236:239], a[252:255], v[80:83]
    buffer_load_dwordx4 a[40:43], v242, s[68:71], s101 offen offset:2048 sc1
    v_mov_b32 v84, 0xc0135761
    v_mov_b32 v85, 0xc0135761
    v_mov_b32 v86, 0xbdd2d3e8
    v_mov_b32 v87, 0xbdd2d3e8
    v_mov_b32 v88, 0x3f800000
    v_mov_b32 v89, 0x3f800000
    s_lshl_b32 s80, s7, 3
    s_lshl_b32 s81, s9, 1
    s_add_u32 s80, s80, s81
    s_mul_i32 s80, s80, 48
    s_mul_i32 s81, s8, 3
    s_add_u32 s80, s80, s81
    s_lshl_b32 s80, s80, 10
    s_add_u32 s80, s80, 0x600000
    s_add_u32 s81, s80, 49152
    v_lshlrev_b32 v2, 4, v1
    v_pk_mul_f32 v[184:185], v[36:37], v[36:37]
    v_pk_mul_f32 v[186:187], v[38:39], v[38:39]
    v_pk_mul_f32 v[188:189], v[44:45], v[44:45]
    v_pk_mul_f32 v[190:191], v[46:47], v[46:47]
    v_pk_fma_f32 v[184:185], v[184:185], v[86:87], v[84:85]
    v_pk_fma_f32 v[186:187], v[186:187], v[86:87], v[84:85]
    v_pk_fma_f32 v[188:189], v[188:189], v[86:87], v[84:85]
    v_pk_fma_f32 v[190:191], v[190:191], v[86:87], v[84:85]
    v_pk_mul_f32 v[184:185], v[184:185], v[36:37]
    v_pk_mul_f32 v[186:187], v[186:187], v[38:39]
    v_pk_mul_f32 v[188:189], v[188:189], v[44:45]
    v_pk_mul_f32 v[190:191], v[190:191], v[46:47]
    buffer_load_dwordx4 a[44:47], v242, s[68:71], s101 offen offset:3072 sc1
    s_add_u32 s101, s101, 4096
    v_exp_f32 v184, v184
    v_exp_f32 v185, v185
    v_exp_f32 v186, v186
    v_exp_f32 v187, v187
    v_exp_f32 v188, v188
    v_exp_f32 v189, v189
    v_exp_f32 v190, v190
    v_exp_f32 v191, v191
    v_pk_add_f32 v[184:185], v[184:185], v[88:89]
    v_pk_add_f32 v[186:187], v[186:187], v[88:89]
    v_pk_add_f32 v[188:189], v[188:189], v[88:89]
    v_pk_add_f32 v[190:191], v[190:191], v[88:89]
    buffer_load_dwordx4 a[48:51], v242, s[68:71], s101 offen offset:0 sc1
    v_rcp_f32 v184, v184
    v_rcp_f32 v185, v185
    v_rcp_f32 v186, v186
    v_rcp_f32 v187, v187
    v_rcp_f32 v188, v188
    v_rcp_f32 v189, v189
    v_rcp_f32 v190, v190
    v_rcp_f32 v191, v191
    v_pk_mul_f32 v[184:185], v[184:185], v[36:37]
    v_pk_mul_f32 v[186:187], v[186:187], v[38:39]
    v_pk_mul_f32 v[188:189], v[188:189], v[44:45]
    v_pk_mul_f32 v[190:191], v[190:191], v[46:47]
    buffer_load_dwordx4 a[52:55], v242, s[68:71], s101 offen offset:1024 sc1
    v_cvt_pk_bf16_f32 v90, v184, v185
    v_cvt_pk_bf16_f32 v91, v186, v187
    v_cvt_pk_bf16_f32 v92, v188, v189
    v_cvt_pk_bf16_f32 v93, v190, v191
    buffer_store_dwordx4 v[90:93], v2, s[68:71], s80 offen offset:0 sc1
    v_pk_mul_f32 v[200:201], v[52:53], v[52:53]
    v_pk_mul_f32 v[202:203], v[54:55], v[54:55]
    v_pk_mul_f32 v[204:205], v[60:61], v[60:61]
    v_pk_mul_f32 v[206:207], v[62:63], v[62:63]
    v_pk_fma_f32 v[200:201], v[200:201], v[86:87], v[84:85]
    v_pk_fma_f32 v[202:203], v[202:203], v[86:87], v[84:85]
    v_pk_fma_f32 v[204:205], v[204:205], v[86:87], v[84:85]
    v_pk_fma_f32 v[206:207], v[206:207], v[86:87], v[84:85]
    v_pk_mul_f32 v[200:201], v[200:201], v[52:53]
    v_pk_mul_f32 v[202:203], v[202:203], v[54:55]
    v_pk_mul_f32 v[204:205], v[204:205], v[60:61]
    v_pk_mul_f32 v[206:207], v[206:207], v[62:63]
    buffer_load_dwordx4 a[56:59], v242, s[68:71], s101 offen offset:2048 sc1
    v_exp_f32 v200, v200
    v_exp_f32 v201, v201
    v_exp_f32 v202, v202
    v_exp_f32 v203, v203
    v_exp_f32 v204, v204
    v_exp_f32 v205, v205
    v_exp_f32 v206, v206
    v_exp_f32 v207, v207
    v_pk_add_f32 v[200:201], v[200:201], v[88:89]
    v_pk_add_f32 v[202:203], v[202:203], v[88:89]
    v_pk_add_f32 v[204:205], v[204:205], v[88:89]
    v_pk_add_f32 v[206:207], v[206:207], v[88:89]
    buffer_load_dwordx4 a[60:63], v242, s[68:71], s101 offen offset:3072 sc1
    s_add_u32 s101, s101, 4096
    v_rcp_f32 v200, v200
    v_rcp_f32 v201, v201
    v_rcp_f32 v202, v202
    v_rcp_f32 v203, v203
    v_rcp_f32 v204, v204
    v_rcp_f32 v205, v205
    v_rcp_f32 v206, v206
    v_rcp_f32 v207, v207
    v_pk_mul_f32 v[200:201], v[200:201], v[52:53]
    v_pk_mul_f32 v[202:203], v[202:203], v[54:55]
    v_pk_mul_f32 v[204:205], v[204:205], v[60:61]
    v_pk_mul_f32 v[206:207], v[206:207], v[62:63]
    buffer_load_dwordx4 a[64:67], v242, s[68:71], s101 offen offset:0 sc1
    v_cvt_pk_bf16_f32 v94, v200, v201
    v_cvt_pk_bf16_f32 v95, v202, v203
    v_cvt_pk_bf16_f32 v96, v204, v205
    v_cvt_pk_bf16_f32 v97, v206, v207
    buffer_store_dwordx4 v[94:97], v2, s[68:71], s80 offen offset:1024 sc1
    v_pk_mul_f32 v[184:185], v[68:69], v[68:69]
    v_pk_mul_f32 v[186:187], v[70:71], v[70:71]
    v_pk_mul_f32 v[188:189], v[76:77], v[76:77]
    v_pk_mul_f32 v[190:191], v[78:79], v[78:79]
    v_pk_fma_f32 v[184:185], v[184:185], v[86:87], v[84:85]
    v_pk_fma_f32 v[186:187], v[186:187], v[86:87], v[84:85]
    v_pk_fma_f32 v[188:189], v[188:189], v[86:87], v[84:85]
    v_pk_fma_f32 v[190:191], v[190:191], v[86:87], v[84:85]
    v_pk_mul_f32 v[184:185], v[184:185], v[68:69]
    v_pk_mul_f32 v[186:187], v[186:187], v[70:71]
    v_pk_mul_f32 v[188:189], v[188:189], v[76:77]
    v_pk_mul_f32 v[190:191], v[190:191], v[78:79]
    buffer_load_dwordx4 a[68:71], v242, s[68:71], s101 offen offset:1024 sc1
    v_exp_f32 v184, v184
    v_exp_f32 v185, v185
    v_exp_f32 v186, v186
    v_exp_f32 v187, v187
    v_exp_f32 v188, v188
    v_exp_f32 v189, v189
    v_exp_f32 v190, v190
    v_exp_f32 v191, v191
    v_pk_add_f32 v[184:185], v[184:185], v[88:89]
    v_pk_add_f32 v[186:187], v[186:187], v[88:89]
    v_pk_add_f32 v[188:189], v[188:189], v[88:89]
    v_pk_add_f32 v[190:191], v[190:191], v[88:89]
    buffer_load_dwordx4 a[72:75], v242, s[68:71], s101 offen offset:2048 sc1
    v_rcp_f32 v184, v184
    v_rcp_f32 v185, v185
    v_rcp_f32 v186, v186
    v_rcp_f32 v187, v187
    v_rcp_f32 v188, v188
    v_rcp_f32 v189, v189
    v_rcp_f32 v190, v190
    v_rcp_f32 v191, v191
    v_pk_mul_f32 v[184:185], v[184:185], v[68:69]
    v_pk_mul_f32 v[186:187], v[186:187], v[70:71]
    v_pk_mul_f32 v[188:189], v[188:189], v[76:77]
    v_pk_mul_f32 v[190:191], v[190:191], v[78:79]
    buffer_load_dwordx4 a[76:79], v242, s[68:71], s101 offen offset:3072 sc1
    s_add_u32 s101, s101, 4096
    v_cvt_pk_bf16_f32 v98, v184, v185
    v_cvt_pk_bf16_f32 v99, v186, v187
    v_cvt_pk_bf16_f32 v100, v188, v189
    v_cvt_pk_bf16_f32 v101, v190, v191
    buffer_store_dwordx4 v[98:101], v2, s[68:71], s80 offen offset:2048 sc1
    v_pk_mul_f32 v[200:201], v[40:41], v[40:41]
    v_pk_mul_f32 v[202:203], v[42:43], v[42:43]
    v_pk_mul_f32 v[204:205], v[48:49], v[48:49]
    v_pk_mul_f32 v[206:207], v[50:51], v[50:51]
    v_pk_fma_f32 v[200:201], v[200:201], v[86:87], v[84:85]
    v_pk_fma_f32 v[202:203], v[202:203], v[86:87], v[84:85]
    v_pk_fma_f32 v[204:205], v[204:205], v[86:87], v[84:85]
    v_pk_fma_f32 v[206:207], v[206:207], v[86:87], v[84:85]
    v_pk_mul_f32 v[200:201], v[200:201], v[40:41]
    v_pk_mul_f32 v[202:203], v[202:203], v[42:43]
    v_pk_mul_f32 v[204:205], v[204:205], v[48:49]
    v_pk_mul_f32 v[206:207], v[206:207], v[50:51]
    buffer_load_dwordx4 a[80:83], v242, s[68:71], s101 offen offset:0 sc1
    v_exp_f32 v200, v200
    v_exp_f32 v201, v201
    v_exp_f32 v202, v202
    v_exp_f32 v203, v203
    v_exp_f32 v204, v204
    v_exp_f32 v205, v205
    v_exp_f32 v206, v206
    v_exp_f32 v207, v207
    v_pk_add_f32 v[200:201], v[200:201], v[88:89]
    v_pk_add_f32 v[202:203], v[202:203], v[88:89]
    v_pk_add_f32 v[204:205], v[204:205], v[88:89]
    v_pk_add_f32 v[206:207], v[206:207], v[88:89]
    buffer_load_dwordx4 a[84:87], v242, s[68:71], s101 offen offset:1024 sc1
    v_rcp_f32 v200, v200
    v_rcp_f32 v201, v201
    v_rcp_f32 v202, v202
    v_rcp_f32 v203, v203
    v_rcp_f32 v204, v204
    v_rcp_f32 v205, v205
    v_rcp_f32 v206, v206
    v_rcp_f32 v207, v207
    v_pk_mul_f32 v[200:201], v[200:201], v[40:41]
    v_pk_mul_f32 v[202:203], v[202:203], v[42:43]
    v_pk_mul_f32 v[204:205], v[204:205], v[48:49]
    v_pk_mul_f32 v[206:207], v[206:207], v[50:51]
    buffer_load_dwordx4 a[88:91], v242, s[68:71], s101 offen offset:2048 sc1
    v_cvt_pk_bf16_f32 v102, v200, v201
    v_cvt_pk_bf16_f32 v103, v202, v203
    v_cvt_pk_bf16_f32 v104, v204, v205
    v_cvt_pk_bf16_f32 v105, v206, v207
    buffer_store_dwordx4 v[102:105], v2, s[68:71], s81 offen offset:0 sc1
    v_pk_mul_f32 v[184:185], v[56:57], v[56:57]
    v_pk_mul_f32 v[186:187], v[58:59], v[58:59]
    v_pk_mul_f32 v[188:189], v[64:65], v[64:65]
    v_pk_mul_f32 v[190:191], v[66:67], v[66:67]
    v_pk_fma_f32 v[184:185], v[184:185], v[86:87], v[84:85]
    v_pk_fma_f32 v[186:187], v[186:187], v[86:87], v[84:85]
    v_pk_fma_f32 v[188:189], v[188:189], v[86:87], v[84:85]
    v_pk_fma_f32 v[190:191], v[190:191], v[86:87], v[84:85]
    v_pk_mul_f32 v[184:185], v[184:185], v[56:57]
    v_pk_mul_f32 v[186:187], v[186:187], v[58:59]
    v_pk_mul_f32 v[188:189], v[188:189], v[64:65]
    v_pk_mul_f32 v[190:191], v[190:191], v[66:67]
    buffer_load_dwordx4 a[92:95], v242, s[68:71], s101 offen offset:3072 sc1
    s_add_u32 s101, s101, 4096
    v_exp_f32 v184, v184
    v_exp_f32 v185, v185
    v_exp_f32 v186, v186
    v_exp_f32 v187, v187
    v_exp_f32 v188, v188
    v_exp_f32 v189, v189
    v_exp_f32 v190, v190
    v_exp_f32 v191, v191
    v_pk_add_f32 v[184:185], v[184:185], v[88:89]
    v_pk_add_f32 v[186:187], v[186:187], v[88:89]
    v_pk_add_f32 v[188:189], v[188:189], v[88:89]
    v_pk_add_f32 v[190:191], v[190:191], v[88:89]
    buffer_load_dwordx4 a[96:99], v242, s[68:71], s101 offen offset:0 sc1
    v_rcp_f32 v184, v184
    v_rcp_f32 v185, v185
    v_rcp_f32 v186, v186
    v_rcp_f32 v187, v187
    v_rcp_f32 v188, v188
    v_rcp_f32 v189, v189
    v_rcp_f32 v190, v190
    v_rcp_f32 v191, v191
    v_pk_mul_f32 v[184:185], v[184:185], v[56:57]
    v_pk_mul_f32 v[186:187], v[186:187], v[58:59]
    v_pk_mul_f32 v[188:189], v[188:189], v[64:65]
    v_pk_mul_f32 v[190:191], v[190:191], v[66:67]
    buffer_load_dwordx4 a[100:103], v242, s[68:71], s101 offen offset:1024 sc1
    v_cvt_pk_bf16_f32 v90, v184, v185
    v_cvt_pk_bf16_f32 v91, v186, v187
    v_cvt_pk_bf16_f32 v92, v188, v189
    v_cvt_pk_bf16_f32 v93, v190, v191
    buffer_store_dwordx4 v[90:93], v2, s[68:71], s81 offen offset:1024 sc1
    v_pk_mul_f32 v[200:201], v[72:73], v[72:73]
    v_pk_mul_f32 v[202:203], v[74:75], v[74:75]
    v_pk_mul_f32 v[204:205], v[80:81], v[80:81]
    v_pk_mul_f32 v[206:207], v[82:83], v[82:83]
    v_pk_fma_f32 v[200:201], v[200:201], v[86:87], v[84:85]
    v_pk_fma_f32 v[202:203], v[202:203], v[86:87], v[84:85]
    v_pk_fma_f32 v[204:205], v[204:205], v[86:87], v[84:85]
    v_pk_fma_f32 v[206:207], v[206:207], v[86:87], v[84:85]
    v_pk_mul_f32 v[200:201], v[200:201], v[72:73]
    v_pk_mul_f32 v[202:203], v[202:203], v[74:75]
    v_pk_mul_f32 v[204:205], v[204:205], v[80:81]
    v_pk_mul_f32 v[206:207], v[206:207], v[82:83]
    buffer_load_dwordx4 a[104:107], v242, s[68:71], s101 offen offset:2048 sc1
    v_exp_f32 v200, v200
    v_exp_f32 v201, v201
    v_exp_f32 v202, v202
    v_exp_f32 v203, v203
    v_exp_f32 v204, v204
    v_exp_f32 v205, v205
    v_exp_f32 v206, v206
    v_exp_f32 v207, v207
    v_pk_add_f32 v[200:201], v[200:201], v[88:89]
    v_pk_add_f32 v[202:203], v[202:203], v[88:89]
    v_pk_add_f32 v[204:205], v[204:205], v[88:89]
    v_pk_add_f32 v[206:207], v[206:207], v[88:89]
    buffer_load_dwordx4 a[108:111], v242, s[68:71], s101 offen offset:3072 sc1
    s_add_u32 s101, s101, 4096
    v_rcp_f32 v200, v200
    v_rcp_f32 v201, v201
    v_rcp_f32 v202, v202
    v_rcp_f32 v203, v203
    v_rcp_f32 v204, v204
    v_rcp_f32 v205, v205
    v_rcp_f32 v206, v206
    v_rcp_f32 v207, v207
    v_pk_mul_f32 v[200:201], v[200:201], v[72:73]
    v_pk_mul_f32 v[202:203], v[202:203], v[74:75]
    v_pk_mul_f32 v[204:205], v[204:205], v[80:81]
    v_pk_mul_f32 v[206:207], v[206:207], v[82:83]
    buffer_load_dwordx4 a[112:115], v242, s[68:71], s101 offen offset:0 sc1
    v_cvt_pk_bf16_f32 v94, v200, v201
    v_cvt_pk_bf16_f32 v95, v202, v203
    v_cvt_pk_bf16_f32 v96, v204, v205
    v_cvt_pk_bf16_f32 v97, v206, v207
    buffer_store_dwordx4 v[94:97], v2, s[68:71], s81 offen offset:2048 sc1
    v_lshlrev_b32 v2, 4, v0
    s_waitcnt vmcnt(63)
    v_alignbit_b32 v36, v221, v220, 16
    v_alignbit_b32 v37, v222, v221, 16
    v_alignbit_b32 v38, v223, v222, 16
    v_alignbit_b32 v39, v224, v223, 16
    ds_write_b128 v2, v[222:225] offset:12528
    v_mov_b32 v40, v221
    v_mov_b32 v41, v222
    v_mov_b32 v42, v223
    v_mov_b32 v43, v224
    ds_write_b128 v2, v[36:39] offset:48
    v_mov_b32 v44, v37
    v_mov_b32 v45, v38
    v_mov_b32 v46, v39
    v_alignbit_b32 v47, v225, v224, 16
    ds_write_b128 v2, v[40:43] offset:4208
    ds_write_b128 v2, v[44:47] offset:8368
    v_alignbit_b32 v48, v227, v226, 16
    v_alignbit_b32 v49, v228, v227, 16
    v_alignbit_b32 v50, v229, v228, 16
    v_alignbit_b32 v51, v230, v229, 16
    ds_write_b128 v2, v[228:231] offset:38384
    v_mov_b32 v52, v227
    v_mov_b32 v53, v228
    v_mov_b32 v54, v229
    v_mov_b32 v55, v230
    ds_write_b128 v2, v[48:51] offset:25904
    v_mov_b32 v56, v49
    v_mov_b32 v57, v50
    v_mov_b32 v58, v51
    v_alignbit_b32 v59, v231, v230, 16
    ds_write_b128 v2, v[52:55] offset:30064
    ds_write_b128 v2, v[56:59] offset:34224
    v_alignbit_b32 v60, v233, v232, 16
    v_alignbit_b32 v61, v234, v233, 16
    v_alignbit_b32 v62, v235, v234, 16
    v_alignbit_b32 v63, v236, v235, 16
    ds_write_b128 v2, v[234:237] offset:64240
    v_mov_b32 v64, v233
    v_mov_b32 v65, v234
    v_mov_b32 v66, v235
    v_mov_b32 v67, v236
    ds_write_b128 v2, v[60:63] offset:51760
    v_mov_b32 v68, v61
    v_mov_b32 v69, v62
    v_mov_b32 v70, v63
    v_alignbit_b32 v71, v237, v236, 16
    ds_write_b128 v2, v[64:67] offset:55920
    ds_write_b128 v2, v[68:71] offset:60080
    v_lshlrev_b32 v2, 4, v0
    v_add_u32 v4, 16648, v2
    v_add_u32 v5, 42504, v2
    v_add_u32 v6, 68360, v2
    s_waitcnt vmcnt(35)
    ds_write_b128 v4, v[140:143] offset:4648
    ds_write2_b64 v4, v[140:141], v[142:143] offset0:0 offset1:1
    ds_write_b128 v5, v[144:147] offset:4648
    ds_write2_b64 v5, v[144:145], v[146:147] offset0:0 offset1:1
    ds_write_b128 v6, v[148:151] offset:4648
    ds_write2_b64 v6, v[148:149], v[150:151] offset0:0 offset1:1
    v_and_b32 v2, 15, v1
    v_lshrrev_b32 v3, 4, v1
    v_and_b32 v4, 3, v1
    v_lshrrev_b32 v5, 2, v2
    v_add_u32 v5, v5, v3
    v_mul_u32_u24 v4, 4160, v4
    v_lshl_add_u32 v28, v5, 4, v4
    v_and_b32 v4, 1, v1
    v_lshrrev_b32 v5, 1, v2
    v_lshlrev_b32 v5, 6, v5
    v_lshlrev_b32 v6, 4, v3
    v_mul_u32_u24 v7, 4640, v4
    v_add_u32 v7, v7, v6
    v_sub_u32 v7, v7, v5
    v_add_u32 v29, 17104, v7
    v_add_u32 v5, v5, v6
    v_lshl_add_u32 v31, v4, 3, v5
    v_sub_u32 v30, 21800, v31
    s_cmp_eq_u32 s9, 3
    s_cselect_b32 s82, 0, s9
    s_cmp_eq_u32 s82, 1
    s_cselect_b32 s83, s91, s90
    s_cmp_eq_u32 s82, 2
    s_cselect_b32 s83, s92, s83
    s_mov_b32 s84, s91
    s_mul_i32 s80, s82, 25856
    v_add_u32 v16, s80, v28
    v_add_u32 v17, s80, v29
    v_add_u32 v18, s80, v30
    s_lshl_b32 s81, s83, 12
    s_add_u32 s81, s81, 0x300000
    v_add_u32 v19, s81, v31
    s_mov_b32 s80, 25856
    v_add_u32 v20, s80, v28
    v_add_u32 v21, s80, v29
    v_add_u32 v22, s80, v30
    s_lshl_b32 s81, s84, 12
    s_add_u32 s81, s81, 0x300000
    v_add_u32 v23, s81, v31
    s_lshl_b32 s80, s93, 16
    s_and_b32 s93, s93, 0xffff0000
    s_bitcmp0_b32 s83, 0
    s_cselect_b32 s93, s80, s93
    s_lshl_b32 s80, s94, 16
    s_and_b32 s94, s94, 0xffff0000
    s_bitcmp0_b32 s84, 0
    s_cselect_b32 s94, s80, s94
    buffer_load_dwordx4 a[116:119], v242, s[68:71], s101 offen offset:1024 sc1
    buffer_load_dwordx4 a[120:123], v242, s[68:71], s101 offen offset:2048 sc1
    s_waitcnt lgkmcnt(0)
    s_waitcnt vmcnt(2)
    s_barrier
    s_cmp_lg_u32 s9, 0
    s_cbranch_scc1 L_fs_13
    s_lshl_b32 s12, s7, 11
    s_lshl_b32 s13, s8, 7
    s_add_u32 s12, s12, s13
    s_add_u32 s12, s12, 0xf10000
    v_mov_b32 v244, s10
    v_mov_b32 v245, s11
    v_mov_b32 v243, s12
    s_mov_b64 exec, 1
    buffer_store_dwordx2 v[244:245], v243, s[68:71], 0 offen sc1
    s_mov_b64 exec, -1
L_fs_13:
    s_cmp_eq_u32 s9, 3
    s_cbranch_scc1 L_bot2_15
    s_and_b32 s84, s5, 1
    s_add_u32 s84, s84, s9
    s_cmp_ge_u32 s84, 3
    s_cbranch_scc1 L_bot1_14
    ds_read_b128 v[32:35], v16 offset:0
    ds_read_b128 v[92:95], v17 offset:0
    ds_read_b128 v[88:91], v17 offset:512
    ds_read_b128 v[84:87], v17 offset:1024
    ds_read_b128 v[72:75], v17 offset:2560
    ds_read_b128 v[36:39], v16 offset:512
    ds_read_b128 v[80:83], v17 offset:1536
    ds_read_b128 v[68:71], v17 offset:3072
    ds_read_b128 v[40:43], v16 offset:1024
    ds_read_b128 v[76:79], v17 offset:2048
    ds_read_b128 v[64:67], v17 offset:3584
    ds_read_b128 v[44:47], v16 offset:1536
    ds_read_b128 v[48:51], v16 offset:2048
    ds_read_b128 v[52:55], v16 offset:2560
    ds_read_b128 v[56:59], v16 offset:3072
    ds_read_b128 v[60:63], v16 offset:3584
    s_waitcnt lgkmcnt(14)
    v_mfma_f32_16x16x32_bf16 v[112:115], v[32:35], v[92:95], 0
    ds_read_b128 v[92:95], v17 offset:64
    s_waitcnt lgkmcnt(14)
    v_mfma_f32_16x16x32_bf16 v[116:119], v[32:35], v[88:91], 0
    s_waitcnt lgkmcnt(13)
    v_mfma_f32_16x16x32_bf16 v[120:123], v[32:35], v[84:87], 0
    s_waitcnt lgkmcnt(12)
    v_mfma_f32_16x16x32_bf16 v[124:127], v[32:35], v[72:75], 0
    ds_read_b128 v[32:35], v16 offset:64
    buffer_load_dwordx4 a[124:127], v242, s[68:71], s101 offen offset:3072 sc1
    s_add_u32 s101, s101, 4096
    s_waitcnt lgkmcnt(12)
    v_mfma_f32_16x16x32_bf16 v[112:115], v[36:39], v[88:91], v[112:115]
    ds_read_b128 v[88:91], v17 offset:576
    v_mfma_f32_16x16x32_bf16 v[116:119], v[36:39], v[84:87], v[116:119]
    s_waitcnt lgkmcnt(12)
    v_mfma_f32_16x16x32_bf16 v[120:123], v[36:39], v[80:83], v[120:123]
    s_waitcnt lgkmcnt(11)
    v_mfma_f32_16x16x32_bf16 v[124:127], v[36:39], v[68:71], v[124:127]
    ds_read_b128 v[36:39], v16 offset:576
    buffer_load_dwordx4 a[128:131], v242, s[68:71], s101 offen offset:0 sc1
    s_waitcnt lgkmcnt(11)
    v_mfma_f32_16x16x32_bf16 v[112:115], v[40:43], v[84:87], v[112:115]
    ds_read_b128 v[84:87], v17 offset:1088
    v_mfma_f32_16x16x32_bf16 v[116:119], v[40:43], v[80:83], v[116:119]
    s_waitcnt lgkmcnt(11)
    v_mfma_f32_16x16x32_bf16 v[120:123], v[40:43], v[76:79], v[120:123]
    s_waitcnt lgkmcnt(10)
    v_mfma_f32_16x16x32_bf16 v[124:127], v[40:43], v[64:67], v[124:127]
    ds_read_b128 v[40:43], v16 offset:1088
    buffer_load_dwordx4 a[132:135], v242, s[68:71], s101 offen offset:1024 sc1
    s_waitcnt lgkmcnt(10)
    v_mfma_f32_16x16x32_bf16 v[112:115], v[44:47], v[80:83], v[112:115]
    ds_read_b128 v[80:83], v17 offset:1600
    v_mfma_f32_16x16x32_bf16 v[116:119], v[44:47], v[76:79], v[116:119]
    v_mfma_f32_16x16x32_bf16 v[120:123], v[44:47], v[72:75], v[120:123]
    ds_read_b128 v[44:47], v16 offset:1600
    s_waitcnt lgkmcnt(11)
    v_mfma_f32_16x16x32_bf16 v[112:115], v[48:51], v[76:79], v[112:115]
    ds_read_b128 v[76:79], v17 offset:2112
    buffer_load_dwordx4 a[136:139], v242, s[68:71], s101 offen offset:2048 sc1
    v_mfma_f32_16x16x32_bf16 v[116:119], v[48:51], v[72:75], v[116:119]
    v_mfma_f32_16x16x32_bf16 v[120:123], v[48:51], v[68:71], v[120:123]
    ds_read_b128 v[48:51], v16 offset:2112
    s_waitcnt lgkmcnt(12)
    v_mfma_f32_16x16x32_bf16 v[112:115], v[52:55], v[72:75], v[112:115]
    ds_read_b128 v[72:75], v17 offset:2624
    v_mfma_f32_16x16x32_bf16 v[116:119], v[52:55], v[68:71], v[116:119]
    buffer_load_dwordx4 a[140:143], v242, s[68:71], s101 offen offset:3072 sc1
    s_add_u32 s101, s101, 4096
    v_mfma_f32_16x16x32_bf16 v[120:123], v[52:55], v[64:67], v[120:123]
    ds_read_b128 v[52:55], v16 offset:2624
    s_waitcnt lgkmcnt(13)
    v_mfma_f32_16x16x32_bf16 v[112:115], v[56:59], v[68:71], v[112:115]
    ds_read_b128 v[68:71], v17 offset:3136
    v_mfma_f32_16x16x32_bf16 v[116:119], v[56:59], v[64:67], v[116:119]
    ds_read_b128 v[56:59], v16 offset:3136
    s_waitcnt lgkmcnt(14)
    v_mfma_f32_16x16x32_bf16 v[112:115], v[60:63], v[64:67], v[112:115]
    ds_read_b128 v[60:63], v16 offset:3648
    ds_read_b128 v[64:67], v17 offset:3648
    buffer_load_dwordx4 a[144:147], v242, s[68:71], s101 offen offset:0 sc1
    s_waitcnt lgkmcnt(14)
    v_mfma_f32_16x16x32_bf16 v[112:115], v[32:35], v[92:95], v[112:115]
    ds_read_b128 v[92:95], v17 offset:128
    s_waitcnt lgkmcnt(14)
    v_mfma_f32_16x16x32_bf16 v[116:119], v[32:35], v[88:91], v[116:119]
    s_waitcnt lgkmcnt(12)
    v_mfma_f32_16x16x32_bf16 v[120:123], v[32:35], v[84:87], v[120:123]
    s_waitcnt lgkmcnt(6)
    v_mfma_f32_16x16x32_bf16 v[124:127], v[32:35], v[72:75], v[124:127]
    ds_read_b128 v[32:35], v16 offset:128
    buffer_load_dwordx4 a[148:151], v242, s[68:71], s101 offen offset:1024 sc1
    v_mfma_f32_16x16x32_bf16 v[112:115], v[36:39], v[88:91], v[112:115]
    ds_read_b128 v[88:91], v17 offset:640
    v_mfma_f32_16x16x32_bf16 v[116:119], v[36:39], v[84:87], v[116:119]
    v_mfma_f32_16x16x32_bf16 v[120:123], v[36:39], v[80:83], v[120:123]
    s_waitcnt lgkmcnt(6)
    v_mfma_f32_16x16x32_bf16 v[124:127], v[36:39], v[68:71], v[124:127]
    ds_read_b128 v[36:39], v16 offset:640
    buffer_load_dwordx4 a[152:155], v242, s[68:71], s101 offen offset:2048 sc1
    v_mfma_f32_16x16x32_bf16 v[112:115], v[40:43], v[84:87], v[112:115]
    ds_read_b128 v[84:87], v17 offset:1152
    v_mfma_f32_16x16x32_bf16 v[116:119], v[40:43], v[80:83], v[116:119]
    v_mfma_f32_16x16x32_bf16 v[120:123], v[40:43], v[76:79], v[120:123]
    s_waitcnt lgkmcnt(5)
    v_mfma_f32_16x16x32_bf16 v[124:127], v[40:43], v[64:67], v[124:127]
    ds_read_b128 v[40:43], v16 offset:1152
    buffer_load_dwordx4 a[156:159], v242, s[68:71], s101 offen offset:3072 sc1
    s_add_u32 s101, s101, 4096
    v_mfma_f32_16x16x32_bf16 v[112:115], v[44:47], v[80:83], v[112:115]
    ds_read_b128 v[80:83], v17 offset:1664
    v_mfma_f32_16x16x32_bf16 v[116:119], v[44:47], v[76:79], v[116:119]
    v_mfma_f32_16x16x32_bf16 v[120:123], v[44:47], v[72:75], v[120:123]
    ds_read_b128 v[44:47], v16 offset:1664
    v_mfma_f32_16x16x32_bf16 v[112:115], v[48:51], v[76:79], v[112:115]
    ds_read_b128 v[76:79], v17 offset:2176
    buffer_load_dwordx4 a[160:163], v242, s[68:71], s101 offen offset:0 sc1
    v_mfma_f32_16x16x32_bf16 v[116:119], v[48:51], v[72:75], v[116:119]
    v_mfma_f32_16x16x32_bf16 v[120:123], v[48:51], v[68:71], v[120:123]
    ds_read_b128 v[48:51], v16 offset:2176
    v_mfma_f32_16x16x32_bf16 v[112:115], v[52:55], v[72:75], v[112:115]
    ds_read_b128 v[72:75], v17 offset:2688
    v_mfma_f32_16x16x32_bf16 v[116:119], v[52:55], v[68:71], v[116:119]
    buffer_load_dwordx4 a[164:167], v242, s[68:71], s101 offen offset:1024 sc1
    v_mfma_f32_16x16x32_bf16 v[120:123], v[52:55], v[64:67], v[120:123]
    ds_read_b128 v[52:55], v16 offset:2688
    v_mfma_f32_16x16x32_bf16 v[112:115], v[56:59], v[68:71], v[112:115]
    ds_read_b128 v[68:71], v17 offset:3200
    v_mfma_f32_16x16x32_bf16 v[116:119], v[56:59], v[64:67], v[116:119]
    ds_read_b128 v[56:59], v16 offset:3200
    v_mfma_f32_16x16x32_bf16 v[112:115], v[60:63], v[64:67], v[112:115]
    ds_read_b128 v[60:63], v16 offset:3712
    ds_read_b128 v[64:67], v17 offset:3712
    buffer_load_dwordx4 a[168:171], v242, s[68:71], s101 offen offset:2048 sc1
    s_waitcnt lgkmcnt(14)
    v_mfma_f32_16x16x32_bf16 v[112:115], v[32:35], v[92:95], v[112:115]
    ds_read_b128 v[92:95], v17 offset:192
    s_waitcnt lgkmcnt(14)
    v_mfma_f32_16x16x32_bf16 v[116:119], v[32:35], v[88:91], v[116:119]
    s_waitcnt lgkmcnt(12)
    v_mfma_f32_16x16x32_bf16 v[120:123], v[32:35], v[84:87], v[120:123]
    s_waitcnt lgkmcnt(6)
    v_mfma_f32_16x16x32_bf16 v[124:127], v[32:35], v[72:75], v[124:127]
    ds_read_b128 v[32:35], v16 offset:192
    buffer_load_dwordx4 a[172:175], v242, s[68:71], s101 offen offset:3072 sc1
    s_add_u32 s101, s101, 4096
    v_mfma_f32_16x16x32_bf16 v[112:115], v[36:39], v[88:91], v[112:115]
    ds_read_b128 v[88:91], v17 offset:704
    v_mfma_f32_16x16x32_bf16 v[116:119], v[36:39], v[84:87], v[116:119]
    v_mfma_f32_16x16x32_bf16 v[120:123], v[36:39], v[80:83], v[120:123]
    s_waitcnt lgkmcnt(6)
    v_mfma_f32_16x16x32_bf16 v[124:127], v[36:39], v[68:71], v[124:127]
    ds_read_b128 v[36:39], v16 offset:704
    buffer_load_dwordx4 a[176:179], v242, s[68:71], s101 offen offset:0 sc1
    v_mfma_f32_16x16x32_bf16 v[112:115], v[40:43], v[84:87], v[112:115]
    ds_read_b128 v[84:87], v17 offset:1216
    v_mfma_f32_16x16x32_bf16 v[116:119], v[40:43], v[80:83], v[116:119]
    v_mfma_f32_16x16x32_bf16 v[120:123], v[40:43], v[76:79], v[120:123]
    s_waitcnt lgkmcnt(5)
    v_mfma_f32_16x16x32_bf16 v[124:127], v[40:43], v[64:67], v[124:127]
    ds_read_b128 v[40:43], v16 offset:1216
    buffer_load_dwordx4 a[180:183], v242, s[68:71], s101 offen offset:1024 sc1
    v_mfma_f32_16x16x32_bf16 v[112:115], v[44:47], v[80:83], v[112:115]
    ds_read_b128 v[80:83], v17 offset:1728
    v_mfma_f32_16x16x32_bf16 v[116:119], v[44:47], v[76:79], v[116:119]
    v_mfma_f32_16x16x32_bf16 v[120:123], v[44:47], v[72:75], v[120:123]
    ds_read_b128 v[44:47], v16 offset:1728
    v_mfma_f32_16x16x32_bf16 v[112:115], v[48:51], v[76:79], v[112:115]
    ds_read_b128 v[76:79], v17 offset:2240
    buffer_load_dwordx4 a[184:187], v242, s[68:71], s101 offen offset:2048 sc1
    v_mfma_f32_16x16x32_bf16 v[116:119], v[48:51], v[72:75], v[116:119]
    v_mfma_f32_16x16x32_bf16 v[120:123], v[48:51], v[68:71], v[120:123]
    ds_read_b128 v[48:51], v16 offset:2240
    v_mfma_f32_16x16x32_bf16 v[112:115], v[52:55], v[72:75], v[112:115]
    ds_read_b128 v[72:75], v17 offset:2752
    v_mfma_f32_16x16x32_bf16 v[116:119], v[52:55], v[68:71], v[116:119]
    buffer_load_dwordx4 a[188:191], v242, s[68:71], s101 offen offset:3072 sc1
    s_add_u32 s101, s101, 4096
    v_mfma_f32_16x16x32_bf16 v[120:123], v[52:55], v[64:67], v[120:123]
    ds_read_b128 v[52:55], v16 offset:2752
    v_mfma_f32_16x16x32_bf16 v[112:115], v[56:59], v[68:71], v[112:115]
    ds_read_b128 v[68:71], v17 offset:3264
    v_mfma_f32_16x16x32_bf16 v[116:119], v[56:59], v[64:67], v[116:119]
    ds_read_b128 v[56:59], v16 offset:3264
    v_mfma_f32_16x16x32_bf16 v[112:115], v[60:63], v[64:67], v[112:115]
    ds_read_b128 v[60:63], v16 offset:3776
    ds_read_b128 v[64:67], v17 offset:3776
    buffer_load_dwordx4 a[192:195], v242, s[68:71], s101 offen offset:0 sc1
    s_waitcnt lgkmcnt(14)
    v_mfma_f32_16x16x32_bf16 v[112:115], v[32:35], v[92:95], v[112:115]
    ds_read_b128 v[92:95], v17 offset:256
    s_waitcnt lgkmcnt(14)
    v_mfma_f32_16x16x32_bf16 v[116:119], v[32:35], v[88:91], v[116:119]
    s_waitcnt lgkmcnt(12)
    v_mfma_f32_16x16x32_bf16 v[120:123], v[32:35], v[84:87], v[120:123]
    s_waitcnt lgkmcnt(6)
    v_mfma_f32_16x16x32_bf16 v[124:127], v[32:35], v[72:75], v[124:127]
    ds_read_b128 v[32:35], v16 offset:256
    buffer_load_dwordx4 a[196:199], v242, s[68:71], s101 offen offset:1024 sc1
    v_mfma_f32_16x16x32_bf16 v[112:115], v[36:39], v[88:91], v[112:115]
    ds_read_b128 v[88:91], v17 offset:768
    v_mfma_f32_16x16x32_bf16 v[116:119], v[36:39], v[84:87], v[116:119]
    v_mfma_f32_16x16x32_bf16 v[120:123], v[36:39], v[80:83], v[120:123]
    s_waitcnt lgkmcnt(6)
    v_mfma_f32_16x16x32_bf16 v[124:127], v[36:39], v[68:71], v[124:127]
    ds_read_b128 v[36:39], v16 offset:768
    buffer_load_dwordx4 a[200:203], v242, s[68:71], s101 offen offset:2048 sc1
    v_mfma_f32_16x16x32_bf16 v[112:115], v[40:43], v[84:87], v[112:115]
    ds_read_b128 v[84:87], v17 offset:1280
    v_mfma_f32_16x16x32_bf16 v[116:119], v[40:43], v[80:83], v[116:119]
    v_mfma_f32_16x16x32_bf16 v[120:123], v[40:43], v[76:79], v[120:123]
    s_waitcnt lgkmcnt(5)
    v_mfma_f32_16x16x32_bf16 v[124:127], v[40:43], v[64:67], v[124:127]
    ds_read_b128 v[40:43], v16 offset:1280
    buffer_load_dwordx4 a[204:207], v242, s[68:71], s101 offen offset:3072 sc1
    s_add_u32 s101, s101, 4096
    v_mfma_f32_16x16x32_bf16 v[112:115], v[44:47], v[80:83], v[112:115]
    ds_read_b128 v[80:83], v17 offset:1792
    v_mfma_f32_16x16x32_bf16 v[116:119], v[44:47], v[76:79], v[116:119]
    v_mfma_f32_16x16x32_bf16 v[120:123], v[44:47], v[72:75], v[120:123]
    ds_read_b128 v[44:47], v16 offset:1792
    v_mfma_f32_16x16x32_bf16 v[112:115], v[48:51], v[76:79], v[112:115]
    ds_read_b128 v[76:79], v17 offset:2304
    buffer_load_dwordx4 a[208:211], v242, s[68:71], s101 offen offset:0 sc1
    v_mfma_f32_16x16x32_bf16 v[116:119], v[48:51], v[72:75], v[116:119]
    v_mfma_f32_16x16x32_bf16 v[120:123], v[48:51], v[68:71], v[120:123]
    ds_read_b128 v[48:51], v16 offset:2304
    v_mfma_f32_16x16x32_bf16 v[112:115], v[52:55], v[72:75], v[112:115]
    ds_read_b128 v[72:75], v17 offset:2816
    v_mfma_f32_16x16x32_bf16 v[116:119], v[52:55], v[68:71], v[116:119]
    buffer_load_dwordx4 a[212:215], v242, s[68:71], s101 offen offset:1024 sc1
    v_mfma_f32_16x16x32_bf16 v[120:123], v[52:55], v[64:67], v[120:123]
    ds_read_b128 v[52:55], v16 offset:2816
    v_mfma_f32_16x16x32_bf16 v[112:115], v[56:59], v[68:71], v[112:115]
    ds_read_b128 v[68:71], v17 offset:3328
    v_mfma_f32_16x16x32_bf16 v[116:119], v[56:59], v[64:67], v[116:119]
    ds_read_b128 v[56:59], v16 offset:3328
    v_mfma_f32_16x16x32_bf16 v[112:115], v[60:63], v[64:67], v[112:115]
    ds_read_b128 v[60:63], v16 offset:3840
    ds_read_b128 v[64:67], v17 offset:3840
    buffer_load_dwordx4 a[216:219], v242, s[68:71], s101 offen offset:2048 sc1
    s_lshr_b32 s12, s5, 1
    s_lshl_b32 s12, s12, 11
    s_add_u32 s12, s12, 0xf10000
    v_and_b32 v248, 15, v1
    v_lshlrev_b32 v248, 7, v248
    v_add_u32 v248, s12, v248
    buffer_load_dwordx2 v[246:247], v248, s[68:71], 0 offen sc1
    s_waitcnt lgkmcnt(14)
    v_mfma_f32_16x16x32_bf16 v[112:115], v[32:35], v[92:95], v[112:115]
    ds_read_b128 v[92:95], v17 offset:320
    s_waitcnt lgkmcnt(14)
    v_mfma_f32_16x16x32_bf16 v[116:119], v[32:35], v[88:91], v[116:119]
    s_waitcnt lgkmcnt(12)
    v_mfma_f32_16x16x32_bf16 v[120:123], v[32:35], v[84:87], v[120:123]
    s_waitcnt lgkmcnt(6)
    v_mfma_f32_16x16x32_bf16 v[124:127], v[32:35], v[72:75], v[124:127]
    ds_read_b128 v[32:35], v16 offset:320
    buffer_load_dwordx4 a[220:223], v242, s[68:71], s101 offen offset:3072 sc1
    s_add_u32 s101, s101, 4096
    v_mfma_f32_16x16x32_bf16 v[112:115], v[36:39], v[88:91], v[112:115]
    ds_read_b128 v[88:91], v17 offset:832
    v_mfma_f32_16x16x32_bf16 v[116:119], v[36:39], v[84:87], v[116:119]
    v_mfma_f32_16x16x32_bf16 v[120:123], v[36:39], v[80:83], v[120:123]
    s_waitcnt lgkmcnt(6)
    v_mfma_f32_16x16x32_bf16 v[124:127], v[36:39], v[68:71], v[124:127]
    ds_read_b128 v[36:39], v16 offset:832
    buffer_load_dwordx4 a[224:227], v242, s[68:71], s101 offen offset:0 sc1
    v_mfma_f32_16x16x32_bf16 v[112:115], v[40:43], v[84:87], v[112:115]
    ds_read_b128 v[84:87], v17 offset:1344
    v_mfma_f32_16x16x32_bf16 v[116:119], v[40:43], v[80:83], v[116:119]
    v_mfma_f32_16x16x32_bf16 v[120:123], v[40:43], v[76:79], v[120:123]
    s_waitcnt lgkmcnt(5)
    v_mfma_f32_16x16x32_bf16 v[124:127], v[40:43], v[64:67], v[124:127]
    ds_read_b128 v[40:43], v16 offset:1344
    buffer_load_dwordx4 a[228:231], v242, s[68:71], s101 offen offset:1024 sc1
    v_mfma_f32_16x16x32_bf16 v[112:115], v[44:47], v[80:83], v[112:115]
    ds_read_b128 v[80:83], v17 offset:1856
    v_mfma_f32_16x16x32_bf16 v[116:119], v[44:47], v[76:79], v[116:119]
    v_mfma_f32_16x16x32_bf16 v[120:123], v[44:47], v[72:75], v[120:123]
    ds_read_b128 v[44:47], v16 offset:1856
    v_mfma_f32_16x16x32_bf16 v[112:115], v[48:51], v[76:79], v[112:115]
    ds_read_b128 v[76:79], v17 offset:2368
    buffer_load_dwordx4 a[232:235], v242, s[68:71], s101 offen offset:2048 sc1
    v_mfma_f32_16x16x32_bf16 v[116:119], v[48:51], v[72:75], v[116:119]
    v_mfma_f32_16x16x32_bf16 v[120:123], v[48:51], v[68:71], v[120:123]
    ds_read_b128 v[48:51], v16 offset:2368
    v_mfma_f32_16x16x32_bf16 v[112:115], v[52:55], v[72:75], v[112:115]
    ds_read_b128 v[72:75], v17 offset:2880
    v_mfma_f32_16x16x32_bf16 v[116:119], v[52:55], v[68:71], v[116:119]
    buffer_load_dwordx4 a[236:239], v242, s[68:71], s101 offen offset:3072 sc1
    s_add_u32 s101, s101, 4096
    v_mfma_f32_16x16x32_bf16 v[120:123], v[52:55], v[64:67], v[120:123]
    ds_read_b128 v[52:55], v16 offset:2880
    v_mfma_f32_16x16x32_bf16 v[112:115], v[56:59], v[68:71], v[112:115]
    ds_read_b128 v[68:71], v17 offset:3392
    v_mfma_f32_16x16x32_bf16 v[116:119], v[56:59], v[64:67], v[116:119]
    ds_read_b128 v[56:59], v16 offset:3392
    v_mfma_f32_16x16x32_bf16 v[112:115], v[60:63], v[64:67], v[112:115]
    ds_read_b128 v[60:63], v16 offset:3904
    ds_read_b128 v[64:67], v17 offset:3904
    s_waitcnt lgkmcnt(14)
    v_mfma_f32_16x16x32_bf16 v[112:115], v[32:35], v[92:95], v[112:115]
    ds_read_b128 v[92:95], v17 offset:384
    s_waitcnt lgkmcnt(14)
    v_mfma_f32_16x16x32_bf16 v[116:119], v[32:35], v[88:91], v[116:119]
    s_waitcnt lgkmcnt(12)
    v_mfma_f32_16x16x32_bf16 v[120:123], v[32:35], v[84:87], v[120:123]
    s_waitcnt lgkmcnt(6)
    v_mfma_f32_16x16x32_bf16 v[124:127], v[32:35], v[72:75], v[124:127]
    ds_read_b128 v[32:35], v16 offset:384
    v_mfma_f32_16x16x32_bf16 v[112:115], v[36:39], v[88:91], v[112:115]
    ds_read_b128 v[88:91], v17 offset:896
    v_mfma_f32_16x16x32_bf16 v[116:119], v[36:39], v[84:87], v[116:119]
    v_mfma_f32_16x16x32_bf16 v[120:123], v[36:39], v[80:83], v[120:123]
    s_waitcnt lgkmcnt(6)
    v_mfma_f32_16x16x32_bf16 v[124:127], v[36:39], v[68:71], v[124:127]
    ds_read_b128 v[36:39], v16 offset:896
    v_mfma_f32_16x16x32_bf16 v[112:115], v[40:43], v[84:87], v[112:115]
    ds_read_b128 v[84:87], v17 offset:1408
    v_mfma_f32_16x16x32_bf16 v[116:119], v[40:43], v[80:83], v[116:119]
    v_mfma_f32_16x16x32_bf16 v[120:123], v[40:43], v[76:79], v[120:123]
    s_waitcnt lgkmcnt(5)
    v_mfma_f32_16x16x32_bf16 v[124:127], v[40:43], v[64:67], v[124:127]
    ds_read_b128 v[40:43], v16 offset:1408
    v_mfma_f32_16x16x32_bf16 v[112:115], v[44:47], v[80:83], v[112:115]
    ds_read_b128 v[80:83], v17 offset:1920
    v_mfma_f32_16x16x32_bf16 v[116:119], v[44:47], v[76:79], v[116:119]
    v_mfma_f32_16x16x32_bf16 v[120:123], v[44:47], v[72:75], v[120:123]
    ds_read_b128 v[44:47], v16 offset:1920
    v_mfma_f32_16x16x32_bf16 v[112:115], v[48:51], v[76:79], v[112:115]
    ds_read_b128 v[76:79], v17 offset:2432
    v_mfma_f32_16x16x32_bf16 v[116:119], v[48:51], v[72:75], v[116:119]
    v_mfma_f32_16x16x32_bf16 v[120:123], v[48:51], v[68:71], v[120:123]
    ds_read_b128 v[48:51], v16 offset:2432
    v_mfma_f32_16x16x32_bf16 v[112:115], v[52:55], v[72:75], v[112:115]
    ds_read_b128 v[72:75], v17 offset:2944
    v_mfma_f32_16x16x32_bf16 v[116:119], v[52:55], v[68:71], v[116:119]
    v_mfma_f32_16x16x32_bf16 v[120:123], v[52:55], v[64:67], v[120:123]
    ds_read_b128 v[52:55], v16 offset:2944
    v_mfma_f32_16x16x32_bf16 v[112:115], v[56:59], v[68:71], v[112:115]
    ds_read_b128 v[68:71], v17 offset:3456
    v_mfma_f32_16x16x32_bf16 v[116:119], v[56:59], v[64:67], v[116:119]
    ds_read_b128 v[56:59], v16 offset:3456
    v_mfma_f32_16x16x32_bf16 v[112:115], v[60:63], v[64:67], v[112:115]
    ds_read_b128 v[60:63], v16 offset:3968
    ds_read_b128 v[64:67], v17 offset:3968
    s_waitcnt vmcnt(5)
    s_mov_b32 s14, 20000
L_poll_17:
    v_cmp_eq_u64 vcc, s[10:11], v[246:247]
    s_nop 0
    s_cmp_eq_u64 vcc, -1
    s_cbranch_scc1 L_pollok_18
    s_sub_u32 s14, s14, 1
    s_cmp_eq_u32 s14, 0
    s_cbranch_scc1 L_pollok_18
    s_sleep 1
    buffer_load_dwordx2 v[246:247], v248, s[68:71], 0 offen sc1
    s_waitcnt vmcnt(0)
    s_branch L_poll_17
L_pollok_18:
    s_waitcnt lgkmcnt(14)
    v_mfma_f32_16x16x32_bf16 v[112:115], v[32:35], v[92:95], v[112:115]
    ds_read_b128 v[92:95], v17 offset:448
    s_waitcnt lgkmcnt(14)
    v_mfma_f32_16x16x32_bf16 v[116:119], v[32:35], v[88:91], v[116:119]
    s_waitcnt lgkmcnt(12)
    v_mfma_f32_16x16x32_bf16 v[120:123], v[32:35], v[84:87], v[120:123]
    s_waitcnt lgkmcnt(6)
    v_mfma_f32_16x16x32_bf16 v[124:127], v[32:35], v[72:75], v[124:127]
    ds_read_b128 v[32:35], v16 offset:448
    s_add_u32 s100, s9, 1
    s_and_b32 s100, s100, 3
    s_lshl_b32 s95, s5, 2
    s_add_u32 s95, s95, s100
    s_mul_i32 s95, s95, 48
    s_mul_i32 s100, s9, 12
    s_add_u32 s95, s95, s100
    s_lshl_b32 s95, s95, 10
    s_add_u32 s95, s95, 0x600000
    buffer_load_dwordx4 v[144:147], v242, s[68:71], s95 offen offset:0 sc1
    v_mfma_f32_16x16x32_bf16 v[112:115], v[36:39], v[88:91], v[112:115]
    ds_read_b128 v[88:91], v17 offset:960
    v_mfma_f32_16x16x32_bf16 v[116:119], v[36:39], v[84:87], v[116:119]
    v_mfma_f32_16x16x32_bf16 v[120:123], v[36:39], v[80:83], v[120:123]
    s_waitcnt lgkmcnt(6)
    v_mfma_f32_16x16x32_bf16 v[124:127], v[36:39], v[68:71], v[124:127]
    ds_read_b128 v[36:39], v16 offset:960
    buffer_load_dwordx4 v[148:151], v242, s[68:71], s95 offen offset:1024 sc1
    v_mfma_f32_16x16x32_bf16 v[112:115], v[40:43], v[84:87], v[112:115]
    ds_read_b128 v[84:87], v17 offset:1472
    v_mfma_f32_16x16x32_bf16 v[116:119], v[40:43], v[80:83], v[116:119]
    v_mfma_f32_16x16x32_bf16 v[120:123], v[40:43], v[76:79], v[120:123]
    s_waitcnt lgkmcnt(5)
    v_mfma_f32_16x16x32_bf16 v[124:127], v[40:43], v[64:67], v[124:127]
    ds_read_b128 v[40:43], v16 offset:1472
    buffer_load_dwordx4 v[152:155], v242, s[68:71], s95 offen offset:2048 sc1
    v_mfma_f32_16x16x32_bf16 v[112:115], v[44:47], v[80:83], v[112:115]
    ds_read_b128 v[80:83], v17 offset:1984
    v_mfma_f32_16x16x32_bf16 v[116:119], v[44:47], v[76:79], v[116:119]
    v_mfma_f32_16x16x32_bf16 v[120:123], v[44:47], v[72:75], v[120:123]
    ds_read_b128 v[44:47], v16 offset:1984
    v_mfma_f32_16x16x32_bf16 v[112:115], v[48:51], v[76:79], v[112:115]
    ds_read_b128 v[76:79], v17 offset:2496
    buffer_load_dwordx4 v[156:159], v242, s[68:71], s95 offen offset:3072 sc1
    s_add_u32 s95, s95, 4096
    v_mfma_f32_16x16x32_bf16 v[116:119], v[48:51], v[72:75], v[116:119]
    v_mfma_f32_16x16x32_bf16 v[120:123], v[48:51], v[68:71], v[120:123]
    ds_read_b128 v[48:51], v16 offset:2496
    v_mfma_f32_16x16x32_bf16 v[112:115], v[52:55], v[72:75], v[112:115]
    ds_read_b128 v[72:75], v17 offset:3008
    v_mfma_f32_16x16x32_bf16 v[116:119], v[52:55], v[68:71], v[116:119]
    buffer_load_dwordx4 v[160:163], v242, s[68:71], s95 offen offset:0 sc1
    v_mfma_f32_16x16x32_bf16 v[120:123], v[52:55], v[64:67], v[120:123]
    ds_read_b128 v[52:55], v16 offset:3008
    v_mfma_f32_16x16x32_bf16 v[112:115], v[56:59], v[68:71], v[112:115]
    ds_read_b128 v[68:71], v17 offset:3520
    v_mfma_f32_16x16x32_bf16 v[116:119], v[56:59], v[64:67], v[116:119]
    ds_read_b128 v[56:59], v16 offset:3520
    v_mfma_f32_16x16x32_bf16 v[112:115], v[60:63], v[64:67], v[112:115]
    ds_read_b128 v[60:63], v16 offset:4032
    ds_read_b128 v[64:67], v17 offset:4032
    buffer_load_dwordx4 v[164:167], v242, s[68:71], s95 offen offset:1024 sc1
    s_waitcnt lgkmcnt(14)
    v_mfma_f32_16x16x32_bf16 v[112:115], v[32:35], v[92:95], v[112:115]
    s_waitcnt lgkmcnt(13)
    v_mfma_f32_16x16x32_bf16 v[116:119], v[32:35], v[88:91], v[116:119]
    s_waitcnt lgkmcnt(11)
    v_mfma_f32_16x16x32_bf16 v[120:123], v[32:35], v[84:87], v[120:123]
    s_waitcnt lgkmcnt(5)
    v_mfma_f32_16x16x32_bf16 v[124:127], v[32:35], v[72:75], v[124:127]
    ds_read_b64 v[32:33], v18 offset:0
    buffer_load_dwordx4 v[168:171], v242, s[68:71], s95 offen offset:2048 sc1
    v_mfma_f32_16x16x32_bf16 v[112:115], v[36:39], v[88:91], v[112:115]
    v_mfma_f32_16x16x32_bf16 v[116:119], v[36:39], v[84:87], v[116:119]
    v_mfma_f32_16x16x32_bf16 v[120:123], v[36:39], v[80:83], v[120:123]
    s_waitcnt lgkmcnt(4)
    v_mfma_f32_16x16x32_bf16 v[124:127], v[36:39], v[68:71], v[124:127]
    ds_read_b64 v[36:37], v18 offset:512
    buffer_load_dwordx4 v[172:175], v242, s[68:71], s95 offen offset:3072 sc1
    s_add_u32 s95, s95, 4096
    v_mfma_f32_16x16x32_bf16 v[112:115], v[40:43], v[84:87], v[112:115]
    v_mfma_f32_16x16x32_bf16 v[116:119], v[40:43], v[80:83], v[116:119]
    v_mfma_f32_16x16x32_bf16 v[120:123], v[40:43], v[76:79], v[120:123]
    s_waitcnt lgkmcnt(2)
    v_mfma_f32_16x16x32_bf16 v[124:127], v[40:43], v[64:67], v[124:127]
    ds_read_b64 v[40:41], v18 offset:1024
    buffer_load_dwordx4 v[176:179], v242, s[68:71], s95 offen offset:0 sc1
    v_mfma_f32_16x16x32_bf16 v[112:115], v[44:47], v[80:83], v[112:115]
    v_mfma_f32_16x16x32_bf16 v[116:119], v[44:47], v[76:79], v[116:119]
    v_mfma_f32_16x16x32_bf16 v[120:123], v[44:47], v[72:75], v[120:123]
    ds_read_b64 v[44:45], v18 offset:2560
    v_mfma_f32_16x16x32_bf16 v[112:115], v[48:51], v[76:79], v[112:115]
    buffer_load_dwordx4 v[180:183], v242, s[68:71], s95 offen offset:1024 sc1
    v_mfma_f32_16x16x32_bf16 v[116:119], v[48:51], v[72:75], v[116:119]
    v_mfma_f32_16x16x32_bf16 v[120:123], v[48:51], v[68:71], v[120:123]
    v_mfma_f32_16x16x32_bf16 v[112:115], v[52:55], v[72:75], v[112:115]
    v_mfma_f32_16x16x32_bf16 v[116:119], v[52:55], v[68:71], v[116:119]
    buffer_load_dwordx4 v[184:187], v242, s[68:71], s95 offen offset:2048 sc1
    v_mfma_f32_16x16x32_bf16 v[120:123], v[52:55], v[64:67], v[120:123]
    v_mfma_f32_16x16x32_bf16 v[112:115], v[56:59], v[68:71], v[112:115]
    v_mfma_f32_16x16x32_bf16 v[116:119], v[56:59], v[64:67], v[116:119]
    v_mfma_f32_16x16x32_bf16 v[112:115], v[60:63], v[64:67], v[112:115]
    buffer_load_dwordx4 v[188:191], v242, s[68:71], s95 offen offset:3072 sc1
    s_waitcnt lgkmcnt(0)
    v_lshlrev_b32 v11, 16, v44
    v_and_b32 v10, 0xffff0000, v44
    v_lshlrev_b32 v9, 16, v45
    v_and_b32 v8, 0xffff0000, v45
    v_fma_f32 v8, v8, s93, v124
    v_fma_f32 v9, v9, s93, v125
    v_fma_f32 v10, v10, s93, v126
    v_fma_f32 v11, v11, s93, v127
    v_cvt_pk_bf16_f32 v44, v8, v9
    v_cvt_pk_bf16_f32 v45, v10, v11
    buffer_store_dwordx2 v[44:45], v19, s[68:71], 0 offen offset:1024 sc1
    s_waitcnt lgkmcnt(1)
    v_lshlrev_b32 v7, 16, v40
    v_and_b32 v6, 0xffff0000, v40
    v_lshlrev_b32 v5, 16, v41
    v_and_b32 v4, 0xffff0000, v41
    v_fma_f32 v4, v4, s93, v120
    v_fma_f32 v5, v5, s93, v121
    v_fma_f32 v6, v6, s93, v122
    v_fma_f32 v7, v7, s93, v123
    v_cvt_pk_bf16_f32 v40, v4, v5
    v_cvt_pk_bf16_f32 v41, v6, v7
    buffer_store_dwordx2 v[40:41], v19, s[68:71], 0 offen offset:2560 sc1
    s_waitcnt lgkmcnt(2)
    v_lshlrev_b32 v11, 16, v36
    v_and_b32 v10, 0xffff0000, v36
    v_lshlrev_b32 v9, 16, v37
    v_and_b32 v8, 0xffff0000, v37
    v_fma_f32 v8, v8, s93, v116
    v_fma_f32 v9, v9, s93, v117
    v_fma_f32 v10, v10, s93, v118
    v_fma_f32 v11, v11, s93, v119
    v_cvt_pk_bf16_f32 v36, v8, v9
    v_cvt_pk_bf16_f32 v37, v10, v11
    buffer_store_dwordx2 v[36:37], v19, s[68:71], 0 offen offset:3072 sc1
    s_waitcnt lgkmcnt(3)
    v_lshlrev_b32 v7, 16, v32
    v_and_b32 v6, 0xffff0000, v32
    v_lshlrev_b32 v5, 16, v33
    v_and_b32 v4, 0xffff0000, v33
    v_fma_f32 v4, v4, s93, v112
    v_fma_f32 v5, v5, s93, v113
    v_fma_f32 v6, v6, s93, v114
    v_fma_f32 v7, v7, s93, v115
    v_cvt_pk_bf16_f32 v32, v4, v5
    v_cvt_pk_bf16_f32 v33, v6, v7
    buffer_store_dwordx2 v[32:33], v19, s[68:71], 0 offen offset:3584 sc1
    s_branch L_cdone_16
L_bot1_14:
    s_nop 1
    ds_read_b128 v[32:35], v16 offset:0
    ds_read_b128 v[68:71], v17 offset:1536
    ds_read_b128 v[64:67], v17 offset:2048
    ds_read_b128 v[56:59], v17 offset:3072
    ds_read_b128 v[52:55], v17 offset:3584
    ds_read_b128 v[36:39], v16 offset:512
    ds_read_b128 v[60:63], v17 offset:2560
    ds_read_b128 v[40:43], v16 offset:1024
    ds_read_b128 v[44:47], v16 offset:1536
    ds_read_b128 v[48:51], v16 offset:2048
    s_waitcnt lgkmcnt(8)
    v_mfma_f32_16x16x32_bf16 v[112:115], v[32:35], v[68:71], 0
    ds_read_b128 v[68:71], v17 offset:1600
    s_waitcnt lgkmcnt(8)
    v_mfma_f32_16x16x32_bf16 v[116:119], v[32:35], v[64:67], 0
    buffer_load_dwordx4 a[124:127], v242, s[68:71], s101 offen offset:3072 sc1
    s_add_u32 s101, s101, 4096
    s_waitcnt lgkmcnt(7)
    v_mfma_f32_16x16x32_bf16 v[120:123], v[32:35], v[56:59], 0
    s_waitcnt lgkmcnt(6)
    v_mfma_f32_16x16x32_bf16 v[124:127], v[32:35], v[52:55], 0
    ds_read_b128 v[32:35], v16 offset:64
    buffer_load_dwordx4 a[128:131], v242, s[68:71], s101 offen offset:0 sc1
    s_waitcnt lgkmcnt(6)
    v_mfma_f32_16x16x32_bf16 v[112:115], v[36:39], v[64:67], v[112:115]
    ds_read_b128 v[64:67], v17 offset:2112
    s_waitcnt lgkmcnt(6)
    v_mfma_f32_16x16x32_bf16 v[116:119], v[36:39], v[60:63], v[116:119]
    buffer_load_dwordx4 a[132:135], v242, s[68:71], s101 offen offset:1024 sc1
    v_mfma_f32_16x16x32_bf16 v[120:123], v[36:39], v[52:55], v[120:123]
    ds_read_b128 v[36:39], v16 offset:576
    s_waitcnt lgkmcnt(6)
    v_mfma_f32_16x16x32_bf16 v[112:115], v[40:43], v[60:63], v[112:115]
    ds_read_b128 v[60:63], v17 offset:2624
    buffer_load_dwordx4 a[136:139], v242, s[68:71], s101 offen offset:2048 sc1
    v_mfma_f32_16x16x32_bf16 v[116:119], v[40:43], v[56:59], v[116:119]
    ds_read_b128 v[40:43], v16 offset:1088
    s_waitcnt lgkmcnt(7)
    v_mfma_f32_16x16x32_bf16 v[112:115], v[44:47], v[56:59], v[112:115]
    ds_read_b128 v[56:59], v17 offset:3136
    buffer_load_dwordx4 a[140:143], v242, s[68:71], s101 offen offset:3072 sc1
    s_add_u32 s101, s101, 4096
    v_mfma_f32_16x16x32_bf16 v[116:119], v[44:47], v[52:55], v[116:119]
    ds_read_b128 v[44:47], v16 offset:1600
    s_waitcnt lgkmcnt(8)
    v_mfma_f32_16x16x32_bf16 v[112:115], v[48:51], v[52:55], v[112:115]
    ds_read_b128 v[48:51], v16 offset:2112
    ds_read_b128 v[52:55], v17 offset:3648
    buffer_load_dwordx4 a[144:147], v242, s[68:71], s101 offen offset:0 sc1
    s_waitcnt lgkmcnt(8)
    v_mfma_f32_16x16x32_bf16 v[112:115], v[32:35], v[68:71], v[112:115]
    ds_read_b128 v[68:71], v17 offset:1664
    s_waitcnt lgkmcnt(8)
    v_mfma_f32_16x16x32_bf16 v[116:119], v[32:35], v[64:67], v[116:119]
    buffer_load_dwordx4 a[148:151], v242, s[68:71], s101 offen offset:1024 sc1
    s_waitcnt lgkmcnt(4)
    v_mfma_f32_16x16x32_bf16 v[120:123], v[32:35], v[56:59], v[120:123]
    s_waitcnt lgkmcnt(1)
    v_mfma_f32_16x16x32_bf16 v[124:127], v[32:35], v[52:55], v[124:127]
    ds_read_b128 v[32:35], v16 offset:128
    buffer_load_dwordx4 a[152:155], v242, s[68:71], s101 offen offset:2048 sc1
    v_mfma_f32_16x16x32_bf16 v[112:115], v[36:39], v[64:67], v[112:115]
    ds_read_b128 v[64:67], v17 offset:2176
    v_mfma_f32_16x16x32_bf16 v[116:119], v[36:39], v[60:63], v[116:119]
    buffer_load_dwordx4 a[156:159], v242, s[68:71], s101 offen offset:3072 sc1
    s_add_u32 s101, s101, 4096
    v_mfma_f32_16x16x32_bf16 v[120:123], v[36:39], v[52:55], v[120:123]
    ds_read_b128 v[36:39], v16 offset:640
    v_mfma_f32_16x16x32_bf16 v[112:115], v[40:43], v[60:63], v[112:115]
    ds_read_b128 v[60:63], v17 offset:2688
    buffer_load_dwordx4 a[160:163], v242, s[68:71], s101 offen offset:0 sc1
    v_mfma_f32_16x16x32_bf16 v[116:119], v[40:43], v[56:59], v[116:119]
    ds_read_b128 v[40:43], v16 offset:1152
    v_mfma_f32_16x16x32_bf16 v[112:115], v[44:47], v[56:59], v[112:115]
    ds_read_b128 v[56:59], v17 offset:3200
    buffer_load_dwordx4 a[164:167], v242, s[68:71], s101 offen offset:1024 sc1
    v_mfma_f32_16x16x32_bf16 v[116:119], v[44:47], v[52:55], v[116:119]
    ds_read_b128 v[44:47], v16 offset:1664
    v_mfma_f32_16x16x32_bf16 v[112:115], v[48:51], v[52:55], v[112:115]
    ds_read_b128 v[48:51], v16 offset:2176
    ds_read_b128 v[52:55], v17 offset:3712
    buffer_load_dwordx4 a[168:171], v242, s[68:71], s101 offen offset:2048 sc1
    s_waitcnt lgkmcnt(8)
    v_mfma_f32_16x16x32_bf16 v[112:115], v[32:35], v[68:71], v[112:115]
    ds_read_b128 v[68:71], v17 offset:1728
    s_waitcnt lgkmcnt(8)
    v_mfma_f32_16x16x32_bf16 v[116:119], v[32:35], v[64:67], v[116:119]
    buffer_load_dwordx4 a[172:175], v242, s[68:71], s101 offen offset:3072 sc1
    s_add_u32 s101, s101, 4096
    s_waitcnt lgkmcnt(4)
    v_mfma_f32_16x16x32_bf16 v[120:123], v[32:35], v[56:59], v[120:123]
    s_waitcnt lgkmcnt(1)
    v_mfma_f32_16x16x32_bf16 v[124:127], v[32:35], v[52:55], v[124:127]
    ds_read_b128 v[32:35], v16 offset:192
    buffer_load_dwordx4 a[176:179], v242, s[68:71], s101 offen offset:0 sc1
    v_mfma_f32_16x16x32_bf16 v[112:115], v[36:39], v[64:67], v[112:115]
    ds_read_b128 v[64:67], v17 offset:2240
    v_mfma_f32_16x16x32_bf16 v[116:119], v[36:39], v[60:63], v[116:119]
    buffer_load_dwordx4 a[180:183], v242, s[68:71], s101 offen offset:1024 sc1
    v_mfma_f32_16x16x32_bf16 v[120:123], v[36:39], v[52:55], v[120:123]
    ds_read_b128 v[36:39], v16 offset:704
    v_mfma_f32_16x16x32_bf16 v[112:115], v[40:43], v[60:63], v[112:115]
    ds_read_b128 v[60:63], v17 offset:2752
    buffer_load_dwordx4 a[184:187], v242, s[68:71], s101 offen offset:2048 sc1
    v_mfma_f32_16x16x32_bf16 v[116:119], v[40:43], v[56:59], v[116:119]
    ds_read_b128 v[40:43], v16 offset:1216
    v_mfma_f32_16x16x32_bf16 v[112:115], v[44:47], v[56:59], v[112:115]
    ds_read_b128 v[56:59], v17 offset:3264
    buffer_load_dwordx4 a[188:191], v242, s[68:71], s101 offen offset:3072 sc1
    s_add_u32 s101, s101, 4096
    v_mfma_f32_16x16x32_bf16 v[116:119], v[44:47], v[52:55], v[116:119]
    ds_read_b128 v[44:47], v16 offset:1728
    v_mfma_f32_16x16x32_bf16 v[112:115], v[48:51], v[52:55], v[112:115]
    ds_read_b128 v[48:51], v16 offset:2240
    ds_read_b128 v[52:55], v17 offset:3776
    buffer_load_dwordx4 a[192:195], v242, s[68:71], s101 offen offset:0 sc1
    s_waitcnt lgkmcnt(8)
    v_mfma_f32_16x16x32_bf16 v[112:115], v[32:35], v[68:71], v[112:115]
    ds_read_b128 v[68:71], v17 offset:1792
    s_waitcnt lgkmcnt(8)
    v_mfma_f32_16x16x32_bf16 v[116:119], v[32:35], v[64:67], v[116:119]
    buffer_load_dwordx4 a[196:199], v242, s[68:71], s101 offen offset:1024 sc1
    s_waitcnt lgkmcnt(4)
    v_mfma_f32_16x16x32_bf16 v[120:123], v[32:35], v[56:59], v[120:123]
    s_waitcnt lgkmcnt(1)
    v_mfma_f32_16x16x32_bf16 v[124:127], v[32:35], v[52:55], v[124:127]
    ds_read_b128 v[32:35], v16 offset:256
    buffer_load_dwordx4 a[200:203], v242, s[68:71], s101 offen offset:2048 sc1
    v_mfma_f32_16x16x32_bf16 v[112:115], v[36:39], v[64:67], v[112:115]
    ds_read_b128 v[64:67], v17 offset:2304
    v_mfma_f32_16x16x32_bf16 v[116:119], v[36:39], v[60:63], v[116:119]
    buffer_load_dwordx4 a[204:207], v242, s[68:71], s101 offen offset:3072 sc1
    s_add_u32 s101, s101, 4096
    v_mfma_f32_16x16x32_bf16 v[120:123], v[36:39], v[52:55], v[120:123]
    ds_read_b128 v[36:39], v16 offset:768
    v_mfma_f32_16x16x32_bf16 v[112:115], v[40:43], v[60:63], v[112:115]
    ds_read_b128 v[60:63], v17 offset:2816
    buffer_load_dwordx4 a[208:211], v242, s[68:71], s101 offen offset:0 sc1
    v_mfma_f32_16x16x32_bf16 v[116:119], v[40:43], v[56:59], v[116:119]
    ds_read_b128 v[40:43], v16 offset:1280
    v_mfma_f32_16x16x32_bf16 v[112:115], v[44:47], v[56:59], v[112:115]
    ds_read_b128 v[56:59], v17 offset:3328
    buffer_load_dwordx4 a[212:215], v242, s[68:71], s101 offen offset:1024 sc1
    v_mfma_f32_16x16x32_bf16 v[116:119], v[44:47], v[52:55], v[116:119]
    ds_read_b128 v[44:47], v16 offset:1792
    v_mfma_f32_16x16x32_bf16 v[112:115], v[48:51], v[52:55], v[112:115]
    ds_read_b128 v[48:51], v16 offset:2304
    ds_read_b128 v[52:55], v17 offset:3840
    buffer_load_dwordx4 a[216:219], v242, s[68:71], s101 offen offset:2048 sc1
    s_lshr_b32 s12, s5, 1
    s_lshl_b32 s12, s12, 11
    s_add_u32 s12, s12, 0xf10000
    v_and_b32 v248, 15, v1
    v_lshlrev_b32 v248, 7, v248
    v_add_u32 v248, s12, v248
    buffer_load_dwordx2 v[246:247], v248, s[68:71], 0 offen sc1
    s_waitcnt lgkmcnt(8)
    v_mfma_f32_16x16x32_bf16 v[112:115], v[32:35], v[68:71], v[112:115]
    ds_read_b128 v[68:71], v17 offset:1856
    s_waitcnt lgkmcnt(8)
    v_mfma_f32_16x16x32_bf16 v[116:119], v[32:35], v[64:67], v[116:119]
    buffer_load_dwordx4 a[220:223], v242, s[68:71], s101 offen offset:3072 sc1
    s_add_u32 s101, s101, 4096
    s_waitcnt lgkmcnt(4)
    v_mfma_f32_16x16x32_bf16 v[120:123], v[32:35], v[56:59], v[120:123]
    s_waitcnt lgkmcnt(1)
    v_mfma_f32_16x16x32_bf16 v[124:127], v[32:35], v[52:55], v[124:127]
    ds_read_b128 v[32:35], v16 offset:320
    buffer_load_dwordx4 a[224:227], v242, s[68:71], s101 offen offset:0 sc1
    v_mfma_f32_16x16x32_bf16 v[112:115], v[36:39], v[64:67], v[112:115]
    ds_read_b128 v[64:67], v17 offset:2368
    v_mfma_f32_16x16x32_bf16 v[116:119], v[36:39], v[60:63], v[116:119]
    buffer_load_dwordx4 a[228:231], v242, s[68:71], s101 offen offset:1024 sc1
    v_mfma_f32_16x16x32_bf16 v[120:123], v[36:39], v[52:55], v[120:123]
    ds_read_b128 v[36:39], v16 offset:832
    v_mfma_f32_16x16x32_bf16 v[112:115], v[40:43], v[60:63], v[112:115]
    ds_read_b128 v[60:63], v17 offset:2880
    buffer_load_dwordx4 a[232:235], v242, s[68:71], s101 offen offset:2048 sc1
    v_mfma_f32_16x16x32_bf16 v[116:119], v[40:43], v[56:59], v[116:119]
    ds_read_b128 v[40:43], v16 offset:1344
    v_mfma_f32_16x16x32_bf16 v[112:115], v[44:47], v[56:59], v[112:115]
    ds_read_b128 v[56:59], v17 offset:3392
    buffer_load_dwordx4 a[236:239], v242, s[68:71], s101 offen offset:3072 sc1
    s_add_u32 s101, s101, 4096
    v_mfma_f32_16x16x32_bf16 v[116:119], v[44:47], v[52:55], v[116:119]
    ds_read_b128 v[44:47], v16 offset:1856
    v_mfma_f32_16x16x32_bf16 v[112:115], v[48:51], v[52:55], v[112:115]
    ds_read_b128 v[48:51], v16 offset:2368
    ds_read_b128 v[52:55], v17 offset:3904
    s_waitcnt lgkmcnt(8)
    v_mfma_f32_16x16x32_bf16 v[112:115], v[32:35], v[68:71], v[112:115]
    ds_read_b128 v[68:71], v17 offset:1920
    s_waitcnt lgkmcnt(8)
    v_mfma_f32_16x16x32_bf16 v[116:119], v[32:35], v[64:67], v[116:119]
    s_waitcnt lgkmcnt(4)
    v_mfma_f32_16x16x32_bf16 v[120:123], v[32:35], v[56:59], v[120:123]
    s_waitcnt lgkmcnt(1)
    v_mfma_f32_16x16x32_bf16 v[124:127], v[32:35], v[52:55], v[124:127]
    ds_read_b128 v[32:35], v16 offset:384
    v_mfma_f32_16x16x32_bf16 v[112:115], v[36:39], v[64:67], v[112:115]
    ds_read_b128 v[64:67], v17 offset:2432
    v_mfma_f32_16x16x32_bf16 v[116:119], v[36:39], v[60:63], v[116:119]
    v_mfma_f32_16x16x32_bf16 v[120:123], v[36:39], v[52:55], v[120:123]
    ds_read_b128 v[36:39], v16 offset:896
    v_mfma_f32_16x16x32_bf16 v[112:115], v[40:43], v[60:63], v[112:115]
    ds_read_b128 v[60:63], v17 offset:2944
    v_mfma_f32_16x16x32_bf16 v[116:119], v[40:43], v[56:59], v[116:119]
    ds_read_b128 v[40:43], v16 offset:1408
    v_mfma_f32_16x16x32_bf16 v[112:115], v[44:47], v[56:59], v[112:115]
    ds_read_b128 v[56:59], v17 offset:3456
    v_mfma_f32_16x16x32_bf16 v[116:119], v[44:47], v[52:55], v[116:119]
    ds_read_b128 v[44:47], v16 offset:1920
    v_mfma_f32_16x16x32_bf16 v[112:115], v[48:51], v[52:55], v[112:115]
    ds_read_b128 v[48:51], v16 offset:2432
    ds_read_b128 v[52:55], v17 offset:3968
    s_waitcnt vmcnt(5)
    s_mov_b32 s14, 20000
L_poll_19:
    v_cmp_eq_u64 vcc, s[10:11], v[246:247]
    s_nop 0
    s_cmp_eq_u64 vcc, -1
    s_cbranch_scc1 L_pollok_20
    s_sub_u32 s14, s14, 1
    s_cmp_eq_u32 s14, 0
    s_cbranch_scc1 L_pollok_20
    s_sleep 1
    buffer_load_dwordx2 v[246:247], v248, s[68:71], 0 offen sc1
    s_waitcnt vmcnt(0)
    s_branch L_poll_19
L_pollok_20:
    s_waitcnt lgkmcnt(8)
    v_mfma_f32_16x16x32_bf16 v[112:115], v[32:35], v[68:71], v[112:115]
    ds_read_b128 v[68:71], v17 offset:1984
    s_waitcnt lgkmcnt(8)
    v_mfma_f32_16x16x32_bf16 v[116:119], v[32:35], v[64:67], v[116:119]
    s_add_u32 s100, s9, 1
    s_and_b32 s100, s100, 3
    s_lshl_b32 s95, s5, 2
    s_add_u32 s95, s95, s100
    s_mul_i32 s95, s95, 48
    s_mul_i32 s100, s9, 12
    s_add_u32 s95, s95, s100
    s_lshl_b32 s95, s95, 10
    s_add_u32 s95, s95, 0x600000
    buffer_load_dwordx4 v[144:147], v242, s[68:71], s95 offen offset:0 sc1
    s_waitcnt lgkmcnt(4)
    v_mfma_f32_16x16x32_bf16 v[120:123], v[32:35], v[56:59], v[120:123]
    s_waitcnt lgkmcnt(1)
    v_mfma_f32_16x16x32_bf16 v[124:127], v[32:35], v[52:55], v[124:127]
    ds_read_b128 v[32:35], v16 offset:448
    buffer_load_dwordx4 v[148:151], v242, s[68:71], s95 offen offset:1024 sc1
    v_mfma_f32_16x16x32_bf16 v[112:115], v[36:39], v[64:67], v[112:115]
    ds_read_b128 v[64:67], v17 offset:2496
    v_mfma_f32_16x16x32_bf16 v[116:119], v[36:39], v[60:63], v[116:119]
    buffer_load_dwordx4 v[152:155], v242, s[68:71], s95 offen offset:2048 sc1
    v_mfma_f32_16x16x32_bf16 v[120:123], v[36:39], v[52:55], v[120:123]
    ds_read_b128 v[36:39], v16 offset:960
    v_mfma_f32_16x16x32_bf16 v[112:115], v[40:43], v[60:63], v[112:115]
    ds_read_b128 v[60:63], v17 offset:3008
    buffer_load_dwordx4 v[156:159], v242, s[68:71], s95 offen offset:3072 sc1
    s_add_u32 s95, s95, 4096
    v_mfma_f32_16x16x32_bf16 v[116:119], v[40:43], v[56:59], v[116:119]
    ds_read_b128 v[40:43], v16 offset:1472
    v_mfma_f32_16x16x32_bf16 v[112:115], v[44:47], v[56:59], v[112:115]
    ds_read_b128 v[56:59], v17 offset:3520
    buffer_load_dwordx4 v[160:163], v242, s[68:71], s95 offen offset:0 sc1
    v_mfma_f32_16x16x32_bf16 v[116:119], v[44:47], v[52:55], v[116:119]
    ds_read_b128 v[44:47], v16 offset:1984
    v_mfma_f32_16x16x32_bf16 v[112:115], v[48:51], v[52:55], v[112:115]
    ds_read_b128 v[48:51], v16 offset:2496
    ds_read_b128 v[52:55], v17 offset:4032
    buffer_load_dwordx4 v[164:167], v242, s[68:71], s95 offen offset:1024 sc1
    s_waitcnt lgkmcnt(8)
    v_mfma_f32_16x16x32_bf16 v[112:115], v[32:35], v[68:71], v[112:115]
    s_waitcnt lgkmcnt(7)
    v_mfma_f32_16x16x32_bf16 v[116:119], v[32:35], v[64:67], v[116:119]
    buffer_load_dwordx4 v[168:171], v242, s[68:71], s95 offen offset:2048 sc1
    s_waitcnt lgkmcnt(3)
    v_mfma_f32_16x16x32_bf16 v[120:123], v[32:35], v[56:59], v[120:123]
    s_waitcnt lgkmcnt(0)
    v_mfma_f32_16x16x32_bf16 v[124:127], v[32:35], v[52:55], v[124:127]
    ds_read_b64 v[32:33], v18 offset:1536
    buffer_load_dwordx4 v[172:175], v242, s[68:71], s95 offen offset:3072 sc1
    s_add_u32 s95, s95, 4096
    v_mfma_f32_16x16x32_bf16 v[112:115], v[36:39], v[64:67], v[112:115]
    v_mfma_f32_16x16x32_bf16 v[116:119], v[36:39], v[60:63], v[116:119]
    buffer_load_dwordx4 v[176:179], v242, s[68:71], s95 offen offset:0 sc1
    v_mfma_f32_16x16x32_bf16 v[120:123], v[36:39], v[52:55], v[120:123]
    ds_read_b64 v[36:37], v18 offset:2048
    v_mfma_f32_16x16x32_bf16 v[112:115], v[40:43], v[60:63], v[112:115]
    buffer_load_dwordx4 v[180:183], v242, s[68:71], s95 offen offset:1024 sc1
    v_mfma_f32_16x16x32_bf16 v[116:119], v[40:43], v[56:59], v[116:119]
    ds_read_b64 v[40:41], v18 offset:3072
    v_mfma_f32_16x16x32_bf16 v[112:115], v[44:47], v[56:59], v[112:115]
    buffer_load_dwordx4 v[184:187], v242, s[68:71], s95 offen offset:2048 sc1
    v_mfma_f32_16x16x32_bf16 v[116:119], v[44:47], v[52:55], v[116:119]
    ds_read_b64 v[44:45], v18 offset:3584
    v_mfma_f32_16x16x32_bf16 v[112:115], v[48:51], v[52:55], v[112:115]
    buffer_load_dwordx4 v[188:191], v242, s[68:71], s95 offen offset:3072 sc1
    s_waitcnt lgkmcnt(0)
    v_lshlrev_b32 v11, 16, v44
    v_and_b32 v10, 0xffff0000, v44
    v_lshlrev_b32 v9, 16, v45
    v_and_b32 v8, 0xffff0000, v45
    v_fma_f32 v8, v8, s93, v124
    v_fma_f32 v9, v9, s93, v125
    v_fma_f32 v10, v10, s93, v126
    v_fma_f32 v11, v11, s93, v127
    v_cvt_pk_bf16_f32 v44, v8, v9
    v_cvt_pk_bf16_f32 v45, v10, v11
    buffer_store_dwordx2 v[44:45], v19, s[68:71], 0 offen offset:0 sc1
    s_waitcnt lgkmcnt(1)
    v_lshlrev_b32 v7, 16, v40
    v_and_b32 v6, 0xffff0000, v40
    v_lshlrev_b32 v5, 16, v41
    v_and_b32 v4, 0xffff0000, v41
    v_fma_f32 v4, v4, s93, v120
    v_fma_f32 v5, v5, s93, v121
    v_fma_f32 v6, v6, s93, v122
    v_fma_f32 v7, v7, s93, v123
    v_cvt_pk_bf16_f32 v40, v4, v5
    v_cvt_pk_bf16_f32 v41, v6, v7
    buffer_store_dwordx2 v[40:41], v19, s[68:71], 0 offen offset:512 sc1
    s_waitcnt lgkmcnt(2)
    v_lshlrev_b32 v11, 16, v36
    v_and_b32 v10, 0xffff0000, v36
    v_lshlrev_b32 v9, 16, v37
    v_and_b32 v8, 0xffff0000, v37
    v_fma_f32 v8, v8, s93, v116
    v_fma_f32 v9, v9, s93, v117
    v_fma_f32 v10, v10, s93, v118
    v_fma_f32 v11, v11, s93, v119
    v_cvt_pk_bf16_f32 v36, v8, v9
    v_cvt_pk_bf16_f32 v37, v10, v11
    buffer_store_dwordx2 v[36:37], v19, s[68:71], 0 offen offset:1536 sc1
    s_waitcnt lgkmcnt(3)
    v_lshlrev_b32 v7, 16, v32
    v_and_b32 v6, 0xffff0000, v32
    v_lshlrev_b32 v5, 16, v33
    v_and_b32 v4, 0xffff0000, v33
    v_fma_f32 v4, v4, s93, v112
    v_fma_f32 v5, v5, s93, v113
    v_fma_f32 v6, v6, s93, v114
    v_fma_f32 v7, v7, s93, v115
    v_cvt_pk_bf16_f32 v32, v4, v5
    v_cvt_pk_bf16_f32 v33, v6, v7
    buffer_store_dwordx2 v[32:33], v19, s[68:71], 0 offen offset:2048 sc1
    s_branch L_cdone_16
L_bot2_15:
    s_nop 1
    ds_read_b128 v[32:35], v16 offset:0
    ds_read_b128 v[68:71], v17 offset:1536
    ds_read_b128 v[64:67], v17 offset:2048
    ds_read_b128 v[56:59], v17 offset:3072
    ds_read_b128 v[52:55], v17 offset:3584
    ds_read_b128 v[72:75], v20 offset:0
    ds_read_b128 v[108:111], v21 offset:1536
    ds_read_b128 v[104:107], v21 offset:2048
    ds_read_b128 v[96:99], v21 offset:3072
    ds_read_b128 v[92:95], v21 offset:3584
    ds_read_b128 v[36:39], v16 offset:512
    ds_read_b128 v[60:63], v17 offset:2560
    ds_read_b128 v[76:79], v20 offset:512
    ds_read_b128 v[100:103], v21 offset:2560
    ds_read_b128 v[40:43], v16 offset:1024
    ds_read_b128 v[80:83], v20 offset:1024
    ds_read_b128 v[44:47], v16 offset:1536
    ds_read_b128 v[84:87], v20 offset:1536
    ds_read_b128 v[48:51], v16 offset:2048
    ds_read_b128 v[88:91], v20 offset:2048
    s_waitcnt lgkmcnt(15)
    v_mfma_f32_16x16x32_bf16 v[112:115], v[32:35], v[68:71], 0
    ds_read_b128 v[68:71], v17 offset:1600
    s_waitcnt lgkmcnt(15)
    v_mfma_f32_16x16x32_bf16 v[116:119], v[32:35], v[64:67], 0
    s_waitcnt lgkmcnt(15)
    v_mfma_f32_16x16x32_bf16 v[120:123], v[32:35], v[56:59], 0
    s_waitcnt lgkmcnt(15)
    v_mfma_f32_16x16x32_bf16 v[124:127], v[32:35], v[52:55], 0
    ds_read_b128 v[32:35], v16 offset:64
    buffer_load_dwordx4 a[124:127], v242, s[68:71], s101 offen offset:3072 sc1
    s_add_u32 s101, s101, 4096
    s_waitcnt lgkmcnt(15)
    v_mfma_f32_16x16x32_bf16 v[128:131], v[72:75], v[108:111], 0
    ds_read_b128 v[108:111], v21 offset:1600
    s_waitcnt lgkmcnt(15)
    v_mfma_f32_16x16x32_bf16 v[132:135], v[72:75], v[104:107], 0
    s_waitcnt lgkmcnt(14)
    v_mfma_f32_16x16x32_bf16 v[136:139], v[72:75], v[96:99], 0
    s_waitcnt lgkmcnt(13)
    v_mfma_f32_16x16x32_bf16 v[140:143], v[72:75], v[92:95], 0
    ds_read_b128 v[72:75], v20 offset:64
    buffer_load_dwordx4 a[128:131], v242, s[68:71], s101 offen offset:0 sc1
    s_waitcnt lgkmcnt(13)
    v_mfma_f32_16x16x32_bf16 v[112:115], v[36:39], v[64:67], v[112:115]
    ds_read_b128 v[64:67], v17 offset:2112
    s_waitcnt lgkmcnt(13)
    v_mfma_f32_16x16x32_bf16 v[116:119], v[36:39], v[60:63], v[116:119]
    v_mfma_f32_16x16x32_bf16 v[120:123], v[36:39], v[52:55], v[120:123]
    ds_read_b128 v[36:39], v16 offset:576
    s_waitcnt lgkmcnt(13)
    v_mfma_f32_16x16x32_bf16 v[128:131], v[76:79], v[104:107], v[128:131]
    ds_read_b128 v[104:107], v21 offset:2112
    buffer_load_dwordx4 a[132:135], v242, s[68:71], s101 offen offset:1024 sc1
    s_waitcnt lgkmcnt(13)
    v_mfma_f32_16x16x32_bf16 v[132:135], v[76:79], v[100:103], v[132:135]
    v_mfma_f32_16x16x32_bf16 v[136:139], v[76:79], v[92:95], v[136:139]
    ds_read_b128 v[76:79], v20 offset:576
    s_waitcnt lgkmcnt(13)
    v_mfma_f32_16x16x32_bf16 v[112:115], v[40:43], v[60:63], v[112:115]
    ds_read_b128 v[60:63], v17 offset:2624
    v_mfma_f32_16x16x32_bf16 v[116:119], v[40:43], v[56:59], v[116:119]
    ds_read_b128 v[40:43], v16 offset:1088
    buffer_load_dwordx4 a[136:139], v242, s[68:71], s101 offen offset:2048 sc1
    s_waitcnt lgkmcnt(14)
    v_mfma_f32_16x16x32_bf16 v[128:131], v[80:83], v[100:103], v[128:131]
    ds_read_b128 v[100:103], v21 offset:2624
    v_mfma_f32_16x16x32_bf16 v[132:135], v[80:83], v[96:99], v[132:135]
    ds_read_b128 v[80:83], v20 offset:1088
    s_waitcnt lgkmcnt(15)
    v_mfma_f32_16x16x32_bf16 v[112:115], v[44:47], v[56:59], v[112:115]
    ds_read_b128 v[56:59], v17 offset:3136
    v_mfma_f32_16x16x32_bf16 v[116:119], v[44:47], v[52:55], v[116:119]
    ds_read_b128 v[44:47], v16 offset:1600
    buffer_load_dwordx4 a[140:143], v242, s[68:71], s101 offen offset:3072 sc1
    s_add_u32 s101, s101, 4096
    s_waitcnt lgkmcnt(15)
    v_mfma_f32_16x16x32_bf16 v[128:131], v[84:87], v[96:99], v[128:131]
    ds_read_b128 v[96:99], v21 offset:3136
    v_mfma_f32_16x16x32_bf16 v[132:135], v[84:87], v[92:95], v[132:135]
    ds_read_b128 v[84:87], v20 offset:1600
    s_waitcnt lgkmcnt(15)
    v_mfma_f32_16x16x32_bf16 v[112:115], v[48:51], v[52:55], v[112:115]
    ds_read_b128 v[48:51], v16 offset:2112
    ds_read_b128 v[52:55], v17 offset:3648
    s_waitcnt lgkmcnt(15)
    v_mfma_f32_16x16x32_bf16 v[128:131], v[88:91], v[92:95], v[128:131]
    ds_read_b128 v[88:91], v20 offset:2112
    ds_read_b128 v[92:95], v21 offset:3648
    buffer_load_dwordx4 a[144:147], v242, s[68:71], s101 offen offset:0 sc1
    s_waitcnt lgkmcnt(15)
    v_mfma_f32_16x16x32_bf16 v[112:115], v[32:35], v[68:71], v[112:115]
    ds_read_b128 v[68:71], v17 offset:1664
    s_waitcnt lgkmcnt(15)
    v_mfma_f32_16x16x32_bf16 v[116:119], v[32:35], v[64:67], v[116:119]
    s_waitcnt lgkmcnt(8)
    v_mfma_f32_16x16x32_bf16 v[120:123], v[32:35], v[56:59], v[120:123]
    s_waitcnt lgkmcnt(3)
    v_mfma_f32_16x16x32_bf16 v[124:127], v[32:35], v[52:55], v[124:127]
    ds_read_b128 v[32:35], v16 offset:128
    buffer_load_dwordx4 a[148:151], v242, s[68:71], s101 offen offset:1024 sc1
    v_mfma_f32_16x16x32_bf16 v[128:131], v[72:75], v[108:111], v[128:131]
    ds_read_b128 v[108:111], v21 offset:1664
    v_mfma_f32_16x16x32_bf16 v[132:135], v[72:75], v[104:107], v[132:135]
    v_mfma_f32_16x16x32_bf16 v[136:139], v[72:75], v[96:99], v[136:139]
    s_waitcnt lgkmcnt(3)
    v_mfma_f32_16x16x32_bf16 v[140:143], v[72:75], v[92:95], v[140:143]
    ds_read_b128 v[72:75], v20 offset:128
    buffer_load_dwordx4 a[152:155], v242, s[68:71], s101 offen offset:2048 sc1
    v_mfma_f32_16x16x32_bf16 v[112:115], v[36:39], v[64:67], v[112:115]
    ds_read_b128 v[64:67], v17 offset:2176
    v_mfma_f32_16x16x32_bf16 v[116:119], v[36:39], v[60:63], v[116:119]
    v_mfma_f32_16x16x32_bf16 v[120:123], v[36:39], v[52:55], v[120:123]
    ds_read_b128 v[36:39], v16 offset:640
    v_mfma_f32_16x16x32_bf16 v[128:131], v[76:79], v[104:107], v[128:131]
    ds_read_b128 v[104:107], v21 offset:2176
    buffer_load_dwordx4 a[156:159], v242, s[68:71], s101 offen offset:3072 sc1
    s_add_u32 s101, s101, 4096
    v_mfma_f32_16x16x32_bf16 v[132:135], v[76:79], v[100:103], v[132:135]
    v_mfma_f32_16x16x32_bf16 v[136:139], v[76:79], v[92:95], v[136:139]
    ds_read_b128 v[76:79], v20 offset:640
    v_mfma_f32_16x16x32_bf16 v[112:115], v[40:43], v[60:63], v[112:115]
    ds_read_b128 v[60:63], v17 offset:2688
    v_mfma_f32_16x16x32_bf16 v[116:119], v[40:43], v[56:59], v[116:119]
    ds_read_b128 v[40:43], v16 offset:1152
    buffer_load_dwordx4 a[160:163], v242, s[68:71], s101 offen offset:0 sc1
    v_mfma_f32_16x16x32_bf16 v[128:131], v[80:83], v[100:103], v[128:131]
    ds_read_b128 v[100:103], v21 offset:2688
    v_mfma_f32_16x16x32_bf16 v[132:135], v[80:83], v[96:99], v[132:135]
    ds_read_b128 v[80:83], v20 offset:1152
    v_mfma_f32_16x16x32_bf16 v[112:115], v[44:47], v[56:59], v[112:115]
    ds_read_b128 v[56:59], v17 offset:3200
    v_mfma_f32_16x16x32_bf16 v[116:119], v[44:47], v[52:55], v[116:119]
    ds_read_b128 v[44:47], v16 offset:1664
    buffer_load_dwordx4 a[164:167], v242, s[68:71], s101 offen offset:1024 sc1
    v_mfma_f32_16x16x32_bf16 v[128:131], v[84:87], v[96:99], v[128:131]
    ds_read_b128 v[96:99], v21 offset:3200
    v_mfma_f32_16x16x32_bf16 v[132:135], v[84:87], v[92:95], v[132:135]
    ds_read_b128 v[84:87], v20 offset:1664
    v_mfma_f32_16x16x32_bf16 v[112:115], v[48:51], v[52:55], v[112:115]
    ds_read_b128 v[48:51], v16 offset:2176
    ds_read_b128 v[52:55], v17 offset:3712
    v_mfma_f32_16x16x32_bf16 v[128:131], v[88:91], v[92:95], v[128:131]
    ds_read_b128 v[88:91], v20 offset:2176
    ds_read_b128 v[92:95], v21 offset:3712
    buffer_load_dwordx4 a[168:171], v242, s[68:71], s101 offen offset:2048 sc1
    s_waitcnt lgkmcnt(15)
    v_mfma_f32_16x16x32_bf16 v[112:115], v[32:35], v[68:71], v[112:115]
    ds_read_b128 v[68:71], v17 offset:1728
    s_waitcnt lgkmcnt(15)
    v_mfma_f32_16x16x32_bf16 v[116:119], v[32:35], v[64:67], v[116:119]
    s_waitcnt lgkmcnt(8)
    v_mfma_f32_16x16x32_bf16 v[120:123], v[32:35], v[56:59], v[120:123]
    s_waitcnt lgkmcnt(3)
    v_mfma_f32_16x16x32_bf16 v[124:127], v[32:35], v[52:55], v[124:127]
    ds_read_b128 v[32:35], v16 offset:192
    buffer_load_dwordx4 a[172:175], v242, s[68:71], s101 offen offset:3072 sc1
    s_add_u32 s101, s101, 4096
    v_mfma_f32_16x16x32_bf16 v[128:131], v[72:75], v[108:111], v[128:131]
    ds_read_b128 v[108:111], v21 offset:1728
    v_mfma_f32_16x16x32_bf16 v[132:135], v[72:75], v[104:107], v[132:135]
    v_mfma_f32_16x16x32_bf16 v[136:139], v[72:75], v[96:99], v[136:139]
    s_waitcnt lgkmcnt(3)
    v_mfma_f32_16x16x32_bf16 v[140:143], v[72:75], v[92:95], v[140:143]
    ds_read_b128 v[72:75], v20 offset:192
    buffer_load_dwordx4 a[176:179], v242, s[68:71], s101 offen offset:0 sc1
    v_mfma_f32_16x16x32_bf16 v[112:115], v[36:39], v[64:67], v[112:115]
    ds_read_b128 v[64:67], v17 offset:2240
    v_mfma_f32_16x16x32_bf16 v[116:119], v[36:39], v[60:63], v[116:119]
    v_mfma_f32_16x16x32_bf16 v[120:123], v[36:39], v[52:55], v[120:123]
    ds_read_b128 v[36:39], v16 offset:704
    v_mfma_f32_16x16x32_bf16 v[128:131], v[76:79], v[104:107], v[128:131]
    ds_read_b128 v[104:107], v21 offset:2240
    buffer_load_dwordx4 a[180:183], v242, s[68:71], s101 offen offset:1024 sc1
    v_mfma_f32_16x16x32_bf16 v[132:135], v[76:79], v[100:103], v[132:135]
    v_mfma_f32_16x16x32_bf16 v[136:139], v[76:79], v[92:95], v[136:139]
    ds_read_b128 v[76:79], v20 offset:704
    v_mfma_f32_16x16x32_bf16 v[112:115], v[40:43], v[60:63], v[112:115]
    ds_read_b128 v[60:63], v17 offset:2752
    v_mfma_f32_16x16x32_bf16 v[116:119], v[40:43], v[56:59], v[116:119]
    ds_read_b128 v[40:43], v16 offset:1216
    buffer_load_dwordx4 a[184:187], v242, s[68:71], s101 offen offset:2048 sc1
    v_mfma_f32_16x16x32_bf16 v[128:131], v[80:83], v[100:103], v[128:131]
    ds_read_b128 v[100:103], v21 offset:2752
    v_mfma_f32_16x16x32_bf16 v[132:135], v[80:83], v[96:99], v[132:135]
    ds_read_b128 v[80:83], v20 offset:1216
    v_mfma_f32_16x16x32_bf16 v[112:115], v[44:47], v[56:59], v[112:115]
    ds_read_b128 v[56:59], v17 offset:3264
    v_mfma_f32_16x16x32_bf16 v[116:119], v[44:47], v[52:55], v[116:119]
    ds_read_b128 v[44:47], v16 offset:1728
    buffer_load_dwordx4 a[188:191], v242, s[68:71], s101 offen offset:3072 sc1
    s_add_u32 s101, s101, 4096
    v_mfma_f32_16x16x32_bf16 v[128:131], v[84:87], v[96:99], v[128:131]
    ds_read_b128 v[96:99], v21 offset:3264
    v_mfma_f32_16x16x32_bf16 v[132:135], v[84:87], v[92:95], v[132:135]
    ds_read_b128 v[84:87], v20 offset:1728
    v_mfma_f32_16x16x32_bf16 v[112:115], v[48:51], v[52:55], v[112:115]
    ds_read_b128 v[48:51], v16 offset:2240
    ds_read_b128 v[52:55], v17 offset:3776
    v_mfma_f32_16x16x32_bf16 v[128:131], v[88:91], v[92:95], v[128:131]
    ds_read_b128 v[88:91], v20 offset:2240
    ds_read_b128 v[92:95], v21 offset:3776
    buffer_load_dwordx4 a[192:195], v242, s[68:71], s101 offen offset:0 sc1
    s_waitcnt lgkmcnt(15)
    v_mfma_f32_16x16x32_bf16 v[112:115], v[32:35], v[68:71], v[112:115]
    ds_read_b128 v[68:71], v17 offset:1792
    s_waitcnt lgkmcnt(15)
    v_mfma_f32_16x16x32_bf16 v[116:119], v[32:35], v[64:67], v[116:119]
    s_waitcnt lgkmcnt(8)
    v_mfma_f32_16x16x32_bf16 v[120:123], v[32:35], v[56:59], v[120:123]
    s_waitcnt lgkmcnt(3)
    v_mfma_f32_16x16x32_bf16 v[124:127], v[32:35], v[52:55], v[124:127]
    ds_read_b128 v[32:35], v16 offset:256
    buffer_load_dwordx4 a[196:199], v242, s[68:71], s101 offen offset:1024 sc1
    v_mfma_f32_16x16x32_bf16 v[128:131], v[72:75], v[108:111], v[128:131]
    ds_read_b128 v[108:111], v21 offset:1792
    v_mfma_f32_16x16x32_bf16 v[132:135], v[72:75], v[104:107], v[132:135]
    v_mfma_f32_16x16x32_bf16 v[136:139], v[72:75], v[96:99], v[136:139]
    s_waitcnt lgkmcnt(3)
    v_mfma_f32_16x16x32_bf16 v[140:143], v[72:75], v[92:95], v[140:143]
    ds_read_b128 v[72:75], v20 offset:256
    buffer_load_dwordx4 a[200:203], v242, s[68:71], s101 offen offset:2048 sc1
    v_mfma_f32_16x16x32_bf16 v[112:115], v[36:39], v[64:67], v[112:115]
    ds_read_b128 v[64:67], v17 offset:2304
    v_mfma_f32_16x16x32_bf16 v[116:119], v[36:39], v[60:63], v[116:119]
    v_mfma_f32_16x16x32_bf16 v[120:123], v[36:39], v[52:55], v[120:123]
    ds_read_b128 v[36:39], v16 offset:768
    v_mfma_f32_16x16x32_bf16 v[128:131], v[76:79], v[104:107], v[128:131]
    ds_read_b128 v[104:107], v21 offset:2304
    buffer_load_dwordx4 a[204:207], v242, s[68:71], s101 offen offset:3072 sc1
    s_add_u32 s101, s101, 4096
    v_mfma_f32_16x16x32_bf16 v[132:135], v[76:79], v[100:103], v[132:135]
    v_mfma_f32_16x16x32_bf16 v[136:139], v[76:79], v[92:95], v[136:139]
    ds_read_b128 v[76:79], v20 offset:768
    v_mfma_f32_16x16x32_bf16 v[112:115], v[40:43], v[60:63], v[112:115]
    ds_read_b128 v[60:63], v17 offset:2816
    v_mfma_f32_16x16x32_bf16 v[116:119], v[40:43], v[56:59], v[116:119]
    ds_read_b128 v[40:43], v16 offset:1280
    buffer_load_dwordx4 a[208:211], v242, s[68:71], s101 offen offset:0 sc1
    v_mfma_f32_16x16x32_bf16 v[128:131], v[80:83], v[100:103], v[128:131]
    ds_read_b128 v[100:103], v21 offset:2816
    v_mfma_f32_16x16x32_bf16 v[132:135], v[80:83], v[96:99], v[132:135]
    ds_read_b128 v[80:83], v20 offset:1280
    v_mfma_f32_16x16x32_bf16 v[112:115], v[44:47], v[56:59], v[112:115]
    ds_read_b128 v[56:59], v17 offset:3328
    v_mfma_f32_16x16x32_bf16 v[116:119], v[44:47], v[52:55], v[116:119]
    ds_read_b128 v[44:47], v16 offset:1792
    buffer_load_dwordx4 a[212:215], v242, s[68:71], s101 offen offset:1024 sc1
    v_mfma_f32_16x16x32_bf16 v[128:131], v[84:87], v[96:99], v[128:131]
    ds_read_b128 v[96:99], v21 offset:3328
    v_mfma_f32_16x16x32_bf16 v[132:135], v[84:87], v[92:95], v[132:135]
    ds_read_b128 v[84:87], v20 offset:1792
    v_mfma_f32_16x16x32_bf16 v[112:115], v[48:51], v[52:55], v[112:115]
    ds_read_b128 v[48:51], v16 offset:2304
    ds_read_b128 v[52:55], v17 offset:3840
    v_mfma_f32_16x16x32_bf16 v[128:131], v[88:91], v[92:95], v[128:131]
    ds_read_b128 v[88:91], v20 offset:2304
    ds_read_b128 v[92:95], v21 offset:3840
    buffer_load_dwordx4 a[216:219], v242, s[68:71], s101 offen offset:2048 sc1
    s_lshr_b32 s12, s5, 1
    s_lshl_b32 s12, s12, 11
    s_add_u32 s12, s12, 0xf10000
    v_and_b32 v248, 15, v1
    v_lshlrev_b32 v248, 7, v248
    v_add_u32 v248, s12, v248
    buffer_load_dwordx2 v[246:247], v248, s[68:71], 0 offen sc1
    s_waitcnt lgkmcnt(15)
    v_mfma_f32_16x16x32_bf16 v[112:115], v[32:35], v[68:71], v[112:115]
    ds_read_b128 v[68:71], v17 offset:1856
    s_waitcnt lgkmcnt(15)
    v_mfma_f32_16x16x32_bf16 v[116:119], v[32:35], v[64:67], v[116:119]
    s_waitcnt lgkmcnt(8)
    v_mfma_f32_16x16x32_bf16 v[120:123], v[32:35], v[56:59], v[120:123]
    s_waitcnt lgkmcnt(3)
    v_mfma_f32_16x16x32_bf16 v[124:127], v[32:35], v[52:55], v[124:127]
    ds_read_b128 v[32:35], v16 offset:320
    buffer_load_dwordx4 a[220:223], v242, s[68:71], s101 offen offset:3072 sc1
    s_add_u32 s101, s101, 4096
    v_mfma_f32_16x16x32_bf16 v[128:131], v[72:75], v[108:111], v[128:131]
    ds_read_b128 v[108:111], v21 offset:1856
    v_mfma_f32_16x16x32_bf16 v[132:135], v[72:75], v[104:107], v[132:135]
    v_mfma_f32_16x16x32_bf16 v[136:139], v[72:75], v[96:99], v[136:139]
    s_waitcnt lgkmcnt(3)
    v_mfma_f32_16x16x32_bf16 v[140:143], v[72:75], v[92:95], v[140:143]
    ds_read_b128 v[72:75], v20 offset:320
    buffer_load_dwordx4 a[224:227], v242, s[68:71], s101 offen offset:0 sc1
    v_mfma_f32_16x16x32_bf16 v[112:115], v[36:39], v[64:67], v[112:115]
    ds_read_b128 v[64:67], v17 offset:2368
    v_mfma_f32_16x16x32_bf16 v[116:119], v[36:39], v[60:63], v[116:119]
    v_mfma_f32_16x16x32_bf16 v[120:123], v[36:39], v[52:55], v[120:123]
    ds_read_b128 v[36:39], v16 offset:832
    v_mfma_f32_16x16x32_bf16 v[128:131], v[76:79], v[104:107], v[128:131]
    ds_read_b128 v[104:107], v21 offset:2368
    buffer_load_dwordx4 a[228:231], v242, s[68:71], s101 offen offset:1024 sc1
    v_mfma_f32_16x16x32_bf16 v[132:135], v[76:79], v[100:103], v[132:135]
    v_mfma_f32_16x16x32_bf16 v[136:139], v[76:79], v[92:95], v[136:139]
    ds_read_b128 v[76:79], v20 offset:832
    v_mfma_f32_16x16x32_bf16 v[112:115], v[40:43], v[60:63], v[112:115]
    ds_read_b128 v[60:63], v17 offset:2880
    v_mfma_f32_16x16x32_bf16 v[116:119], v[40:43], v[56:59], v[116:119]
    ds_read_b128 v[40:43], v16 offset:1344
    buffer_load_dwordx4 a[232:235], v242, s[68:71], s101 offen offset:2048 sc1
    v_mfma_f32_16x16x32_bf16 v[128:131], v[80:83], v[100:103], v[128:131]
    ds_read_b128 v[100:103], v21 offset:2880
    v_mfma_f32_16x16x32_bf16 v[132:135], v[80:83], v[96:99], v[132:135]
    ds_read_b128 v[80:83], v20 offset:1344
    v_mfma_f32_16x16x32_bf16 v[112:115], v[44:47], v[56:59], v[112:115]
    ds_read_b128 v[56:59], v17 offset:3392
    v_mfma_f32_16x16x32_bf16 v[116:119], v[44:47], v[52:55], v[116:119]
    ds_read_b128 v[44:47], v16 offset:1856
    buffer_load_dwordx4 a[236:239], v242, s[68:71], s101 offen offset:3072 sc1
    s_add_u32 s101, s101, 4096
    v_mfma_f32_16x16x32_bf16 v[128:131], v[84:87], v[96:99], v[128:131]
    ds_read_b128 v[96:99], v21 offset:3392
    v_mfma_f32_16x16x32_bf16 v[132:135], v[84:87], v[92:95], v[132:135]
    ds_read_b128 v[84:87], v20 offset:1856
    v_mfma_f32_16x16x32_bf16 v[112:115], v[48:51], v[52:55], v[112:115]
    ds_read_b128 v[48:51], v16 offset:2368
    ds_read_b128 v[52:55], v17 offset:3904
    v_mfma_f32_16x16x32_bf16 v[128:131], v[88:91], v[92:95], v[128:131]
    ds_read_b128 v[88:91], v20 offset:2368
    ds_read_b128 v[92:95], v21 offset:3904
    s_waitcnt lgkmcnt(15)
    v_mfma_f32_16x16x32_bf16 v[112:115], v[32:35], v[68:71], v[112:115]
    ds_read_b128 v[68:71], v17 offset:1920
    s_waitcnt lgkmcnt(15)
    v_mfma_f32_16x16x32_bf16 v[116:119], v[32:35], v[64:67], v[116:119]
    s_waitcnt lgkmcnt(8)
    v_mfma_f32_16x16x32_bf16 v[120:123], v[32:35], v[56:59], v[120:123]
    s_waitcnt lgkmcnt(3)
    v_mfma_f32_16x16x32_bf16 v[124:127], v[32:35], v[52:55], v[124:127]
    ds_read_b128 v[32:35], v16 offset:384
    v_mfma_f32_16x16x32_bf16 v[128:131], v[72:75], v[108:111], v[128:131]
    ds_read_b128 v[108:111], v21 offset:1920
    v_mfma_f32_16x16x32_bf16 v[132:135], v[72:75], v[104:107], v[132:135]
    v_mfma_f32_16x16x32_bf16 v[136:139], v[72:75], v[96:99], v[136:139]
    s_waitcnt lgkmcnt(3)
    v_mfma_f32_16x16x32_bf16 v[140:143], v[72:75], v[92:95], v[140:143]
    ds_read_b128 v[72:75], v20 offset:384
    v_mfma_f32_16x16x32_bf16 v[112:115], v[36:39], v[64:67], v[112:115]
    ds_read_b128 v[64:67], v17 offset:2432
    v_mfma_f32_16x16x32_bf16 v[116:119], v[36:39], v[60:63], v[116:119]
    v_mfma_f32_16x16x32_bf16 v[120:123], v[36:39], v[52:55], v[120:123]
    ds_read_b128 v[36:39], v16 offset:896
    v_mfma_f32_16x16x32_bf16 v[128:131], v[76:79], v[104:107], v[128:131]
    ds_read_b128 v[104:107], v21 offset:2432
    v_mfma_f32_16x16x32_bf16 v[132:135], v[76:79], v[100:103], v[132:135]
    v_mfma_f32_16x16x32_bf16 v[136:139], v[76:79], v[92:95], v[136:139]
    ds_read_b128 v[76:79], v20 offset:896
    v_mfma_f32_16x16x32_bf16 v[112:115], v[40:43], v[60:63], v[112:115]
    ds_read_b128 v[60:63], v17 offset:2944
    v_mfma_f32_16x16x32_bf16 v[116:119], v[40:43], v[56:59], v[116:119]
    ds_read_b128 v[40:43], v16 offset:1408
    v_mfma_f32_16x16x32_bf16 v[128:131], v[80:83], v[100:103], v[128:131]
    ds_read_b128 v[100:103], v21 offset:2944
    v_mfma_f32_16x16x32_bf16 v[132:135], v[80:83], v[96:99], v[132:135]
    ds_read_b128 v[80:83], v20 offset:1408
    v_mfma_f32_16x16x32_bf16 v[112:115], v[44:47], v[56:59], v[112:115]
    ds_read_b128 v[56:59], v17 offset:3456
    v_mfma_f32_16x16x32_bf16 v[116:119], v[44:47], v[52:55], v[116:119]
    ds_read_b128 v[44:47], v16 offset:1920
    v_mfma_f32_16x16x32_bf16 v[128:131], v[84:87], v[96:99], v[128:131]
    ds_read_b128 v[96:99], v21 offset:3456
    v_mfma_f32_16x16x32_bf16 v[132:135], v[84:87], v[92:95], v[132:135]
    ds_read_b128 v[84:87], v20 offset:1920
    v_mfma_f32_16x16x32_bf16 v[112:115], v[48:51], v[52:55], v[112:115]
    ds_read_b128 v[48:51], v16 offset:2432
    ds_read_b128 v[52:55], v17 offset:3968
    v_mfma_f32_16x16x32_bf16 v[128:131], v[88:91], v[92:95], v[128:131]
    ds_read_b128 v[88:91], v20 offset:2432
    ds_read_b128 v[92:95], v21 offset:3968
    s_waitcnt vmcnt(5)
    s_mov_b32 s14, 20000
L_poll_21:
    v_cmp_eq_u64 vcc, s[10:11], v[246:247]
    s_nop 0
    s_cmp_eq_u64 vcc, -1
    s_cbranch_scc1 L_pollok_22
    s_sub_u32 s14, s14, 1
    s_cmp_eq_u32 s14, 0
    s_cbranch_scc1 L_pollok_22
    s_sleep 1
    buffer_load_dwordx2 v[246:247], v248, s[68:71], 0 offen sc1
    s_waitcnt vmcnt(0)
    s_branch L_poll_21
L_pollok_22:
    s_waitcnt lgkmcnt(15)
    v_mfma_f32_16x16x32_bf16 v[112:115], v[32:35], v[68:71], v[112:115]
    ds_read_b128 v[68:71], v17 offset:1984
    s_waitcnt lgkmcnt(15)
    v_mfma_f32_16x16x32_bf16 v[116:119], v[32:35], v[64:67], v[116:119]
    s_waitcnt lgkmcnt(8)
    v_mfma_f32_16x16x32_bf16 v[120:123], v[32:35], v[56:59], v[120:123]
    s_waitcnt lgkmcnt(3)
    v_mfma_f32_16x16x32_bf16 v[124:127], v[32:35], v[52:55], v[124:127]
    ds_read_b128 v[32:35], v16 offset:448
    s_add_u32 s100, s9, 1
    s_and_b32 s100, s100, 3
    s_lshl_b32 s95, s5, 2
    s_add_u32 s95, s95, s100
    s_mul_i32 s95, s95, 48
    s_mul_i32 s100, s9, 12
    s_add_u32 s95, s95, s100
    s_lshl_b32 s95, s95, 10
    s_add_u32 s95, s95, 0x600000
    buffer_load_dwordx4 v[144:147], v242, s[68:71], s95 offen offset:0 sc1
    v_mfma_f32_16x16x32_bf16 v[128:131], v[72:75], v[108:111], v[128:131]
    ds_read_b128 v[108:111], v21 offset:1984
    v_mfma_f32_16x16x32_bf16 v[132:135], v[72:75], v[104:107], v[132:135]
    v_mfma_f32_16x16x32_bf16 v[136:139], v[72:75], v[96:99], v[136:139]
    s_waitcnt lgkmcnt(3)
    v_mfma_f32_16x16x32_bf16 v[140:143], v[72:75], v[92:95], v[140:143]
    ds_read_b128 v[72:75], v20 offset:448
    buffer_load_dwordx4 v[148:151], v242, s[68:71], s95 offen offset:1024 sc1
    v_mfma_f32_16x16x32_bf16 v[112:115], v[36:39], v[64:67], v[112:115]
    ds_read_b128 v[64:67], v17 offset:2496
    v_mfma_f32_16x16x32_bf16 v[116:119], v[36:39], v[60:63], v[116:119]
    v_mfma_f32_16x16x32_bf16 v[120:123], v[36:39], v[52:55], v[120:123]
    ds_read_b128 v[36:39], v16 offset:960
    v_mfma_f32_16x16x32_bf16 v[128:131], v[76:79], v[104:107], v[128:131]
    ds_read_b128 v[104:107], v21 offset:2496
    buffer_load_dwordx4 v[152:155], v242, s[68:71], s95 offen offset:2048 sc1
    v_mfma_f32_16x16x32_bf16 v[132:135], v[76:79], v[100:103], v[132:135]
    v_mfma_f32_16x16x32_bf16 v[136:139], v[76:79], v[92:95], v[136:139]
    ds_read_b128 v[76:79], v20 offset:960
    v_mfma_f32_16x16x32_bf16 v[112:115], v[40:43], v[60:63], v[112:115]
    ds_read_b128 v[60:63], v17 offset:3008
    v_mfma_f32_16x16x32_bf16 v[116:119], v[40:43], v[56:59], v[116:119]
    ds_read_b128 v[40:43], v16 offset:1472
    buffer_load_dwordx4 v[156:159], v242, s[68:71], s95 offen offset:3072 sc1
    s_add_u32 s95, s95, 4096
    v_mfma_f32_16x16x32_bf16 v[128:131], v[80:83], v[100:103], v[128:131]
    ds_read_b128 v[100:103], v21 offset:3008
    v_mfma_f32_16x16x32_bf16 v[132:135], v[80:83], v[96:99], v[132:135]
    ds_read_b128 v[80:83], v20 offset:1472
    v_mfma_f32_16x16x32_bf16 v[112:115], v[44:47], v[56:59], v[112:115]
    ds_read_b128 v[56:59], v17 offset:3520
    v_mfma_f32_16x16x32_bf16 v[116:119], v[44:47], v[52:55], v[116:119]
    ds_read_b128 v[44:47], v16 offset:1984
    buffer_load_dwordx4 v[160:163], v242, s[68:71], s95 offen offset:0 sc1
    v_mfma_f32_16x16x32_bf16 v[128:131], v[84:87], v[96:99], v[128:131]
    ds_read_b128 v[96:99], v21 offset:3520
    v_mfma_f32_16x16x32_bf16 v[132:135], v[84:87], v[92:95], v[132:135]
    ds_read_b128 v[84:87], v20 offset:1984
    v_mfma_f32_16x16x32_bf16 v[112:115], v[48:51], v[52:55], v[112:115]
    ds_read_b128 v[48:51], v16 offset:2496
    ds_read_b128 v[52:55], v17 offset:4032
    v_mfma_f32_16x16x32_bf16 v[128:131], v[88:91], v[92:95], v[128:131]
    ds_read_b128 v[88:91], v20 offset:2496
    ds_read_b128 v[92:95], v21 offset:4032
    buffer_load_dwordx4 v[164:167], v242, s[68:71], s95 offen offset:1024 sc1
    s_waitcnt lgkmcnt(15)
    v_mfma_f32_16x16x32_bf16 v[112:115], v[32:35], v[68:71], v[112:115]
    s_waitcnt lgkmcnt(15)
    v_mfma_f32_16x16x32_bf16 v[116:119], v[32:35], v[64:67], v[116:119]
    s_waitcnt lgkmcnt(7)
    v_mfma_f32_16x16x32_bf16 v[120:123], v[32:35], v[56:59], v[120:123]
    s_waitcnt lgkmcnt(2)
    v_mfma_f32_16x16x32_bf16 v[124:127], v[32:35], v[52:55], v[124:127]
    ds_read_b64 v[32:33], v18 offset:1536
    buffer_load_dwordx4 v[168:171], v242, s[68:71], s95 offen offset:2048 sc1
    v_mfma_f32_16x16x32_bf16 v[128:131], v[72:75], v[108:111], v[128:131]
    v_mfma_f32_16x16x32_bf16 v[132:135], v[72:75], v[104:107], v[132:135]
    v_mfma_f32_16x16x32_bf16 v[136:139], v[72:75], v[96:99], v[136:139]
    s_waitcnt lgkmcnt(1)
    v_mfma_f32_16x16x32_bf16 v[140:143], v[72:75], v[92:95], v[140:143]
    ds_read_b64 v[72:73], v22 offset:1536
    buffer_load_dwordx4 v[172:175], v242, s[68:71], s95 offen offset:3072 sc1
    s_add_u32 s95, s95, 4096
    v_mfma_f32_16x16x32_bf16 v[112:115], v[36:39], v[64:67], v[112:115]
    v_mfma_f32_16x16x32_bf16 v[116:119], v[36:39], v[60:63], v[116:119]
    v_mfma_f32_16x16x32_bf16 v[120:123], v[36:39], v[52:55], v[120:123]
    ds_read_b64 v[36:37], v18 offset:2048
    v_mfma_f32_16x16x32_bf16 v[128:131], v[76:79], v[104:107], v[128:131]
    buffer_load_dwordx4 v[176:179], v242, s[68:71], s95 offen offset:0 sc1
    v_mfma_f32_16x16x32_bf16 v[132:135], v[76:79], v[100:103], v[132:135]
    v_mfma_f32_16x16x32_bf16 v[136:139], v[76:79], v[92:95], v[136:139]
    ds_read_b64 v[76:77], v22 offset:2048
    v_mfma_f32_16x16x32_bf16 v[112:115], v[40:43], v[60:63], v[112:115]
    v_mfma_f32_16x16x32_bf16 v[116:119], v[40:43], v[56:59], v[116:119]
    ds_read_b64 v[40:41], v18 offset:3072
    buffer_load_dwordx4 v[180:183], v242, s[68:71], s95 offen offset:1024 sc1
    v_mfma_f32_16x16x32_bf16 v[128:131], v[80:83], v[100:103], v[128:131]
    v_mfma_f32_16x16x32_bf16 v[132:135], v[80:83], v[96:99], v[132:135]
    ds_read_b64 v[80:81], v22 offset:3072
    v_mfma_f32_16x16x32_bf16 v[112:115], v[44:47], v[56:59], v[112:115]
    v_mfma_f32_16x16x32_bf16 v[116:119], v[44:47], v[52:55], v[116:119]
    ds_read_b64 v[44:45], v18 offset:3584
    buffer_load_dwordx4 v[184:187], v242, s[68:71], s95 offen offset:2048 sc1
    v_mfma_f32_16x16x32_bf16 v[128:131], v[84:87], v[96:99], v[128:131]
    v_mfma_f32_16x16x32_bf16 v[132:135], v[84:87], v[92:95], v[132:135]
    ds_read_b64 v[84:85], v22 offset:3584
    v_mfma_f32_16x16x32_bf16 v[112:115], v[48:51], v[52:55], v[112:115]
    v_mfma_f32_16x16x32_bf16 v[128:131], v[88:91], v[92:95], v[128:131]
    buffer_load_dwordx4 v[188:191], v242, s[68:71], s95 offen offset:3072 sc1
    s_waitcnt lgkmcnt(1)
    v_lshlrev_b32 v11, 16, v44
    v_and_b32 v10, 0xffff0000, v44
    v_lshlrev_b32 v9, 16, v45
    v_and_b32 v8, 0xffff0000, v45
    v_fma_f32 v8, v8, s93, v124
    v_fma_f32 v9, v9, s93, v125
    v_fma_f32 v10, v10, s93, v126
    v_fma_f32 v11, v11, s93, v127
    v_cvt_pk_bf16_f32 v44, v8, v9
    v_cvt_pk_bf16_f32 v45, v10, v11
    buffer_store_dwordx2 v[44:45], v19, s[68:71], 0 offen offset:0 sc1
    s_waitcnt lgkmcnt(3)
    v_lshlrev_b32 v7, 16, v40
    v_and_b32 v6, 0xffff0000, v40
    v_lshlrev_b32 v5, 16, v41
    v_and_b32 v4, 0xffff0000, v41
    v_fma_f32 v4, v4, s93, v120
    v_fma_f32 v5, v5, s93, v121
    v_fma_f32 v6, v6, s93, v122
    v_fma_f32 v7, v7, s93, v123
    v_cvt_pk_bf16_f32 v40, v4, v5
    v_cvt_pk_bf16_f32 v41, v6, v7
    buffer_store_dwordx2 v[40:41], v19, s[68:71], 0 offen offset:512 sc1
    s_waitcnt lgkmcnt(5)
    v_lshlrev_b32 v11, 16, v36
    v_and_b32 v10, 0xffff0000, v36
    v_lshlrev_b32 v9, 16, v37
    v_and_b32 v8, 0xffff0000, v37
    v_fma_f32 v8, v8, s93, v116
    v_fma_f32 v9, v9, s93, v117
    v_fma_f32 v10, v10, s93, v118
    v_fma_f32 v11, v11, s93, v119
    v_cvt_pk_bf16_f32 v36, v8, v9
    v_cvt_pk_bf16_f32 v37, v10, v11
    buffer_store_dwordx2 v[36:37], v19, s[68:71], 0 offen offset:1536 sc1
    s_waitcnt lgkmcnt(7)
    v_lshlrev_b32 v7, 16, v32
    v_and_b32 v6, 0xffff0000, v32
    v_lshlrev_b32 v5, 16, v33
    v_and_b32 v4, 0xffff0000, v33
    v_fma_f32 v4, v4, s93, v112
    v_fma_f32 v5, v5, s93, v113
    v_fma_f32 v6, v6, s93, v114
    v_fma_f32 v7, v7, s93, v115
    v_cvt_pk_bf16_f32 v32, v4, v5
    v_cvt_pk_bf16_f32 v33, v6, v7
    buffer_store_dwordx2 v[32:33], v19, s[68:71], 0 offen offset:2048 sc1
    s_waitcnt lgkmcnt(0)
    v_lshlrev_b32 v11, 16, v84
    v_and_b32 v10, 0xffff0000, v84
    v_lshlrev_b32 v9, 16, v85
    v_and_b32 v8, 0xffff0000, v85
    v_fma_f32 v8, v8, s94, v140
    v_fma_f32 v9, v9, s94, v141
    v_fma_f32 v10, v10, s94, v142
    v_fma_f32 v11, v11, s94, v143
    v_cvt_pk_bf16_f32 v84, v8, v9
    v_cvt_pk_bf16_f32 v85, v10, v11
    buffer_store_dwordx2 v[84:85], v23, s[68:71], 0 offen offset:0 sc1
    s_waitcnt lgkmcnt(2)
    v_lshlrev_b32 v7, 16, v80
    v_and_b32 v6, 0xffff0000, v80
    v_lshlrev_b32 v5, 16, v81
    v_and_b32 v4, 0xffff0000, v81
    v_fma_f32 v4, v4, s94, v136
    v_fma_f32 v5, v5, s94, v137
    v_fma_f32 v6, v6, s94, v138
    v_fma_f32 v7, v7, s94, v139
    v_cvt_pk_bf16_f32 v80, v4, v5
    v_cvt_pk_bf16_f32 v81, v6, v7
    buffer_store_dwordx2 v[80:81], v23, s[68:71], 0 offen offset:512 sc1
    s_waitcnt lgkmcnt(4)
    v_lshlrev_b32 v11, 16, v76
    v_and_b32 v10, 0xffff0000, v76
    v_lshlrev_b32 v9, 16, v77
    v_and_b32 v8, 0xffff0000, v77
    v_fma_f32 v8, v8, s94, v132
    v_fma_f32 v9, v9, s94, v133
    v_fma_f32 v10, v10, s94, v134
    v_fma_f32 v11, v11, s94, v135
    v_cvt_pk_bf16_f32 v76, v8, v9
    v_cvt_pk_bf16_f32 v77, v10, v11
    buffer_store_dwordx2 v[76:77], v23, s[68:71], 0 offen offset:1536 sc1
    s_waitcnt lgkmcnt(6)
    v_lshlrev_b32 v7, 16, v72
    v_and_b32 v6, 0xffff0000, v72
    v_lshlrev_b32 v5, 16, v73
    v_and_b32 v4, 0xffff0000, v73
    v_fma_f32 v4, v4, s94, v128
    v_fma_f32 v5, v5, s94, v129
    v_fma_f32 v6, v6, s94, v130
    v_fma_f32 v7, v7, s94, v131
    v_cvt_pk_bf16_f32 v72, v4, v5
    v_cvt_pk_bf16_f32 v73, v6, v7
    buffer_store_dwordx2 v[72:73], v23, s[68:71], 0 offen offset:2048 sc1
L_cdone_16:
    v_lshlrev_b32 v60, 4, v1
    v_and_b32 v10, 15, v1
    v_lshrrev_b32 v11, 4, v1
    s_lshl_b32 s80, s5, 6
    s_lshl_b32 s81, s9, 4
    s_add_u32 s80, s80, s81
    s_mul_i32 s81, s6, 160
    v_add_u32 v10, s80, v10
    v_lshlrev_b32 v4, 3, v11
    v_add_u32 v4, s81, v4
    v_mul_u32_u24 v3, 1280, v10
    v_add_u32 v3, v3, v4
    v_lshlrev_b32 v5, 2, v10
    v_add_u32 v5, 0xe00000, v5
    s_mul_i32 s81, s6, 327680
    s_lshl_b32 s80, s80, 1
    s_add_u32 s80, s80, s81
    s_add_u32 s80, s80, 0x300000
    v_lshrrev_b32 v6, 1, v1
    v_lshlrev_b32 v6, 12, v6
    v_and_b32 v10, 1, v1
    v_lshl_add_u32 v6, v10, 4, v6
    v_add_u32 v6, s80, v6
    s_mul_i32 s80, s9, 2560
    s_add_u32 s80, s80, 143360
    v_add_u32 v7, s80, v60
    v_lshlrev_b32 v8, 3, v1
    v_add_u32 v8, s80, v8
    s_add_u32 s80, s9, 1
    s_and_b32 s80, s80, 3
    s_mul_i32 s80, s80, 15360
    s_add_u32 s80, s80, 81920
    v_add_u32 v12, s80, v60
    s_add_u32 s80, s9, 2
    s_and_b32 s80, s80, 3
    s_mul_i32 s80, s80, 15360
    s_add_u32 s80, s80, 87040
    v_add_u32 v13, s80, v60
    s_add_u32 s80, s9, 3
    s_and_b32 s80, s80, 3
    s_mul_i32 s80, s80, 15360
    s_add_u32 s80, s80, 92160
    v_add_u32 v14, s80, v60
    s_mul_i32 s80, s9, 15360
    s_add_u32 s80, s80, 81920
    v_add_u32 v15, s80, v60
    s_waitcnt vmcnt(15)
    v_mfma_f32_16x16x32_bf16 v[16:19], a[0:3], v[144:147], 0
    v_mfma_f32_16x16x32_bf16 v[20:23], a[4:7], v[144:147], 0
    v_mfma_f32_16x16x32_bf16 v[24:27], a[8:11], v[144:147], 0
    s_add_u32 s100, s9, 2
    s_and_b32 s100, s100, 3
    s_lshl_b32 s95, s5, 2
    s_add_u32 s95, s95, s100
    s_mul_i32 s95, s95, 48
    s_mul_i32 s100, s9, 12
    s_add_u32 s95, s95, s100
    s_lshl_b32 s95, s95, 10
    s_add_u32 s95, s95, 0x600000
    buffer_load_dwordx4 v[192:195], v242, s[68:71], s95 offen offset:0 sc1
    v_mfma_f32_16x16x32_bf16 v[28:31], a[12:15], v[144:147], 0
    v_mfma_f32_16x16x32_bf16 v[32:35], a[16:19], v[144:147], 0
    s_waitcnt vmcnt(15)
    v_mfma_f32_16x16x32_bf16 v[16:19], a[20:23], v[148:151], v[16:19]
    buffer_load_dwordx4 v[196:199], v242, s[68:71], s95 offen offset:1024 sc1
    v_mfma_f32_16x16x32_bf16 v[20:23], a[24:27], v[148:151], v[20:23]
    v_mfma_f32_16x16x32_bf16 v[24:27], a[28:31], v[148:151], v[24:27]
    v_mfma_f32_16x16x32_bf16 v[28:31], a[32:35], v[148:151], v[28:31]
    buffer_load_dwordx4 v[200:203], v242, s[68:71], s95 offen offset:2048 sc1
    v_mfma_f32_16x16x32_bf16 v[32:35], a[36:39], v[148:151], v[32:35]
    s_waitcnt vmcnt(16)
    v_mfma_f32_16x16x32_bf16 v[16:19], a[40:43], v[152:155], v[16:19]
    v_mfma_f32_16x16x32_bf16 v[20:23], a[44:47], v[152:155], v[20:23]
    buffer_load_dwordx4 v[204:207], v242, s[68:71], s95 offen offset:3072 sc1
    s_add_u32 s95, s95, 4096
    v_mfma_f32_16x16x32_bf16 v[24:27], a[48:51], v[152:155], v[24:27]
    v_mfma_f32_16x16x32_bf16 v[28:31], a[52:55], v[152:155], v[28:31]
    v_mfma_f32_16x16x32_bf16 v[32:35], a[56:59], v[152:155], v[32:35]
    buffer_load_dwordx4 v[208:211], v242, s[68:71], s95 offen offset:0 sc1
    s_waitcnt vmcnt(17)
    v_mfma_f32_16x16x32_bf16 v[16:19], a[60:63], v[156:159], v[16:19]
    v_mfma_f32_16x16x32_bf16 v[20:23], a[64:67], v[156:159], v[20:23]
    v_mfma_f32_16x16x32_bf16 v[24:27], a[68:71], v[156:159], v[24:27]
    buffer_load_dwordx4 v[212:215], v242, s[68:71], s95 offen offset:1024 sc1
    v_mfma_f32_16x16x32_bf16 v[28:31], a[72:75], v[156:159], v[28:31]
    v_mfma_f32_16x16x32_bf16 v[32:35], a[76:79], v[156:159], v[32:35]
    s_waitcnt vmcnt(17)
    v_mfma_f32_16x16x32_bf16 v[16:19], a[80:83], v[160:163], v[16:19]
    buffer_load_dwordx4 v[216:219], v242, s[68:71], s95 offen offset:2048 sc1
    v_mfma_f32_16x16x32_bf16 v[20:23], a[84:87], v[160:163], v[20:23]
    v_mfma_f32_16x16x32_bf16 v[24:27], a[88:91], v[160:163], v[24:27]
    v_mfma_f32_16x16x32_bf16 v[28:31], a[92:95], v[160:163], v[28:31]
    buffer_load_dwordx4 v[220:223], v242, s[68:71], s95 offen offset:3072 sc1
    s_add_u32 s95, s95, 4096
    v_mfma_f32_16x16x32_bf16 v[32:35], a[96:99], v[160:163], v[32:35]
    s_waitcnt vmcnt(18)
    v_mfma_f32_16x16x32_bf16 v[16:19], a[100:103], v[164:167], v[16:19]
    v_mfma_f32_16x16x32_bf16 v[20:23], a[104:107], v[164:167], v[20:23]
    buffer_load_dwordx4 v[224:227], v242, s[68:71], s95 offen offset:0 sc1
    v_mfma_f32_16x16x32_bf16 v[24:27], a[108:111], v[164:167], v[24:27]
    v_mfma_f32_16x16x32_bf16 v[28:31], a[112:115], v[164:167], v[28:31]
    v_mfma_f32_16x16x32_bf16 v[32:35], a[116:119], v[164:167], v[32:35]
    buffer_load_dwordx4 v[228:231], v242, s[68:71], s95 offen offset:1024 sc1
    s_waitcnt vmcnt(19)
    v_mfma_f32_16x16x32_bf16 v[16:19], a[120:123], v[168:171], v[16:19]
    v_mfma_f32_16x16x32_bf16 v[20:23], a[124:127], v[168:171], v[20:23]
    v_mfma_f32_16x16x32_bf16 v[24:27], a[128:131], v[168:171], v[24:27]
    buffer_load_dwordx4 v[232:235], v242, s[68:71], s95 offen offset:2048 sc1
    v_mfma_f32_16x16x32_bf16 v[28:31], a[132:135], v[168:171], v[28:31]
    v_mfma_f32_16x16x32_bf16 v[32:35], a[136:139], v[168:171], v[32:35]
    s_waitcnt vmcnt(19)
    v_mfma_f32_16x16x32_bf16 v[16:19], a[140:143], v[172:175], v[16:19]
    buffer_load_dwordx4 v[236:239], v242, s[68:71], s95 offen offset:3072 sc1
    v_mfma_f32_16x16x32_bf16 v[20:23], a[144:147], v[172:175], v[20:23]
    v_mfma_f32_16x16x32_bf16 v[24:27], a[148:151], v[172:175], v[24:27]
    v_mfma_f32_16x16x32_bf16 v[28:31], a[152:155], v[172:175], v[28:31]
    s_add_u32 s100, s9, 3
    s_and_b32 s100, s100, 3
    s_lshl_b32 s95, s5, 2
    s_add_u32 s95, s95, s100
    s_mul_i32 s95, s95, 48
    s_mul_i32 s100, s9, 12
    s_add_u32 s95, s95, s100
    s_lshl_b32 s95, s95, 10
    s_add_u32 s95, s95, 0x600000
    buffer_load_dwordx4 v[64:67], v242, s[68:71], s95 offen offset:0 sc1
    v_mfma_f32_16x16x32_bf16 v[32:35], a[156:159], v[172:175], v[32:35]
    s_waitcnt vmcnt(20)
    v_mfma_f32_16x16x32_bf16 v[16:19], a[160:163], v[176:179], v[16:19]
    v_mfma_f32_16x16x32_bf16 v[20:23], a[164:167], v[176:179], v[20:23]
    buffer_load_dwordx4 v[68:71], v242, s[68:71], s95 offen offset:1024 sc1
    v_mfma_f32_16x16x32_bf16 v[24:27], a[168:171], v[176:179], v[24:27]
    v_mfma_f32_16x16x32_bf16 v[28:31], a[172:175], v[176:179], v[28:31]
    v_mfma_f32_16x16x32_bf16 v[32:35], a[176:179], v[176:179], v[32:35]
    buffer_load_dwordx4 v[72:75], v242, s[68:71], s95 offen offset:2048 sc1
    s_waitcnt vmcnt(21)
    v_mfma_f32_16x16x32_bf16 v[16:19], a[180:183], v[180:183], v[16:19]
    v_mfma_f32_16x16x32_bf16 v[20:23], a[184:187], v[180:183], v[20:23]
    v_mfma_f32_16x16x32_bf16 v[24:27], a[188:191], v[180:183], v[24:27]
    buffer_load_dwordx4 v[76:79], v242, s[68:71], s95 offen offset:3072 sc1
    s_add_u32 s95, s95, 4096
    v_mfma_f32_16x16x32_bf16 v[28:31], a[192:195], v[180:183], v[28:31]
    v_mfma_f32_16x16x32_bf16 v[32:35], a[196:199], v[180:183], v[32:35]
    s_waitcnt vmcnt(21)
    v_mfma_f32_16x16x32_bf16 v[16:19], a[200:203], v[184:187], v[16:19]
    buffer_load_dwordx4 v[80:83], v242, s[68:71], s95 offen offset:0 sc1
    v_mfma_f32_16x16x32_bf16 v[20:23], a[204:207], v[184:187], v[20:23]
    v_mfma_f32_16x16x32_bf16 v[24:27], a[208:211], v[184:187], v[24:27]
    v_mfma_f32_16x16x32_bf16 v[28:31], a[212:215], v[184:187], v[28:31]
    buffer_load_dwordx4 v[84:87], v242, s[68:71], s95 offen offset:1024 sc1
    v_mfma_f32_16x16x32_bf16 v[32:35], a[216:219], v[184:187], v[32:35]
    s_waitcnt vmcnt(22)
    v_mfma_f32_16x16x32_bf16 v[16:19], a[220:223], v[188:191], v[16:19]
    v_mfma_f32_16x16x32_bf16 v[20:23], a[224:227], v[188:191], v[20:23]
    buffer_load_dwordx4 v[88:91], v242, s[68:71], s95 offen offset:2048 sc1
    v_mfma_f32_16x16x32_bf16 v[24:27], a[228:231], v[188:191], v[24:27]
    v_mfma_f32_16x16x32_bf16 v[28:31], a[232:235], v[188:191], v[28:31]
    v_mfma_f32_16x16x32_bf16 v[32:35], a[236:239], v[188:191], v[32:35]
    buffer_load_dwordx4 v[92:95], v242, s[68:71], s95 offen offset:3072 sc1
    s_add_u32 s95, s95, 4096
    s_waitcnt vmcnt(20)
    s_barrier
    s_cmp_lg_u32 s9, 0
    s_cbranch_scc1 L_fs_23
    s_lshl_b32 s12, s6, 12
    s_add_u32 s12, s12, 0xf20000
    s_lshl_b32 s13, s5, 7
    s_add_u32 s12, s12, s13
    v_mov_b32 v244, s10
    v_mov_b32 v245, s11
    v_mov_b32 v243, s12
    s_mov_b64 exec, 1
    buffer_store_dwordx2 v[244:245], v243, s[68:71], 0 offen sc1
    s_mov_b64 exec, -1
L_fs_23:
    s_waitcnt vmcnt(19)
    v_mfma_f32_16x16x32_bf16 v[36:39], a[0:3], v[192:195], 0
    v_mfma_f32_16x16x32_bf16 v[40:43], a[4:7], v[192:195], 0
    v_mfma_f32_16x16x32_bf16 v[44:47], a[8:11], v[192:195], 0
    buffer_load_dwordx4 v[96:99], v242, s[68:71], s95 offen offset:0 sc1
    v_mfma_f32_16x16x32_bf16 v[48:51], a[12:15], v[192:195], 0
    v_mfma_f32_16x16x32_bf16 v[52:55], a[16:19], v[192:195], 0
    s_waitcnt vmcnt(19)
    v_mfma_f32_16x16x32_bf16 v[36:39], a[20:23], v[196:199], v[36:39]
    buffer_load_dwordx4 v[100:103], v242, s[68:71], s95 offen offset:1024 sc1
    v_mfma_f32_16x16x32_bf16 v[40:43], a[24:27], v[196:199], v[40:43]
    v_mfma_f32_16x16x32_bf16 v[44:47], a[28:31], v[196:199], v[44:47]
    v_mfma_f32_16x16x32_bf16 v[48:51], a[32:35], v[196:199], v[48:51]
    buffer_load_dwordx4 v[104:107], v242, s[68:71], s95 offen offset:2048 sc1
    v_mfma_f32_16x16x32_bf16 v[52:55], a[36:39], v[196:199], v[52:55]
    s_waitcnt vmcnt(20)
    v_mfma_f32_16x16x32_bf16 v[36:39], a[40:43], v[200:203], v[36:39]
    ds_write_b128 v12, v[16:19] offset:0
    v_mfma_f32_16x16x32_bf16 v[40:43], a[44:47], v[200:203], v[40:43]
    buffer_load_dwordx4 v[108:111], v242, s[68:71], s95 offen offset:3072 sc1
    v_mfma_f32_16x16x32_bf16 v[44:47], a[48:51], v[200:203], v[44:47]
    ds_write_b128 v12, v[20:23] offset:1024
    v_mfma_f32_16x16x32_bf16 v[48:51], a[52:55], v[200:203], v[48:51]
    ds_write_b128 v12, v[24:27] offset:2048
    v_mfma_f32_16x16x32_bf16 v[52:55], a[56:59], v[200:203], v[52:55]
    global_load_dwordx2 v[122:123], v4, s[36:37] offset:0
    s_waitcnt vmcnt(21)
    v_mfma_f32_16x16x32_bf16 v[36:39], a[60:63], v[204:207], v[36:39]
    ds_write_b128 v12, v[28:31] offset:3072
    v_mfma_f32_16x16x32_bf16 v[40:43], a[64:67], v[204:207], v[40:43]
    ds_write_b128 v12, v[32:35] offset:4096
    v_mfma_f32_16x16x32_bf16 v[44:47], a[68:71], v[204:207], v[44:47]
    global_load_dwordx2 v[124:125], v4, s[36:37] offset:32
    v_mfma_f32_16x16x32_bf16 v[48:51], a[72:75], v[204:207], v[48:51]
    v_mfma_f32_16x16x32_bf16 v[52:55], a[76:79], v[204:207], v[52:55]
    s_waitcnt vmcnt(21)
    v_mfma_f32_16x16x32_bf16 v[36:39], a[80:83], v[208:211], v[36:39]
    global_load_dwordx2 v[126:127], v4, s[36:37] offset:64
    v_mfma_f32_16x16x32_bf16 v[40:43], a[84:87], v[208:211], v[40:43]
    v_mfma_f32_16x16x32_bf16 v[44:47], a[88:91], v[208:211], v[44:47]
    v_mfma_f32_16x16x32_bf16 v[48:51], a[92:95], v[208:211], v[48:51]
    global_load_dwordx2 v[128:129], v4, s[36:37] offset:96
    v_mfma_f32_16x16x32_bf16 v[52:55], a[96:99], v[208:211], v[52:55]
    s_waitcnt vmcnt(22)
    v_mfma_f32_16x16x32_bf16 v[36:39], a[100:103], v[212:215], v[36:39]
    v_mfma_f32_16x16x32_bf16 v[40:43], a[104:107], v[212:215], v[40:43]
    global_load_dwordx2 v[130:131], v4, s[36:37] offset:128
    v_mfma_f32_16x16x32_bf16 v[44:47], a[108:111], v[212:215], v[44:47]
    v_mfma_f32_16x16x32_bf16 v[48:51], a[112:115], v[212:215], v[48:51]
    v_mfma_f32_16x16x32_bf16 v[52:55], a[116:119], v[212:215], v[52:55]
    buffer_load_dwordx2 v[112:113], v3, s[48:51], 0 offen offset:0
    s_waitcnt vmcnt(23)
    v_mfma_f32_16x16x32_bf16 v[36:39], a[120:123], v[216:219], v[36:39]
    v_mfma_f32_16x16x32_bf16 v[40:43], a[124:127], v[216:219], v[40:43]
    v_mfma_f32_16x16x32_bf16 v[44:47], a[128:131], v[216:219], v[44:47]
    buffer_load_dwordx2 v[114:115], v3, s[48:51], 0 offen offset:32
    v_mfma_f32_16x16x32_bf16 v[48:51], a[132:135], v[216:219], v[48:51]
    v_mfma_f32_16x16x32_bf16 v[52:55], a[136:139], v[216:219], v[52:55]
    s_waitcnt vmcnt(23)
    v_mfma_f32_16x16x32_bf16 v[36:39], a[140:143], v[220:223], v[36:39]
    buffer_load_dwordx2 v[116:117], v3, s[48:51], 0 offen offset:64
    v_mfma_f32_16x16x32_bf16 v[40:43], a[144:147], v[220:223], v[40:43]
    v_mfma_f32_16x16x32_bf16 v[44:47], a[148:151], v[220:223], v[44:47]
    v_mfma_f32_16x16x32_bf16 v[48:51], a[152:155], v[220:223], v[48:51]
    buffer_load_dwordx2 v[118:119], v3, s[48:51], 0 offen offset:96
    v_mfma_f32_16x16x32_bf16 v[52:55], a[156:159], v[220:223], v[52:55]
    s_waitcnt vmcnt(24)
    v_mfma_f32_16x16x32_bf16 v[36:39], a[160:163], v[224:227], v[36:39]
    v_mfma_f32_16x16x32_bf16 v[40:43], a[164:167], v[224:227], v[40:43]
    buffer_load_dwordx2 v[120:121], v3, s[48:51], 0 offen offset:128
    v_mfma_f32_16x16x32_bf16 v[44:47], a[168:171], v[224:227], v[44:47]
    v_mfma_f32_16x16x32_bf16 v[48:51], a[172:175], v[224:227], v[48:51]
    v_mfma_f32_16x16x32_bf16 v[52:55], a[176:179], v[224:227], v[52:55]
    buffer_load_dword v132, v5, s[68:71], 0 offen sc1
    s_waitcnt vmcnt(25)
    v_mfma_f32_16x16x32_bf16 v[36:39], a[180:183], v[228:231], v[36:39]
    v_mfma_f32_16x16x32_bf16 v[40:43], a[184:187], v[228:231], v[40:43]
    v_mfma_f32_16x16x32_bf16 v[44:47], a[188:191], v[228:231], v[44:47]
    s_add_u32 s100, s9, 4
    s_and_b32 s100, s100, 3
    s_lshl_b32 s95, s5, 2
    s_add_u32 s95, s95, s100
    s_mul_i32 s95, s95, 48
    s_mul_i32 s100, s9, 12
    s_add_u32 s95, s95, s100
    s_lshl_b32 s95, s95, 10
    s_add_u32 s95, s95, 0x600000
    buffer_load_dwordx4 v[144:147], v242, s[68:71], s95 offen offset:0 sc1
    v_mfma_f32_16x16x32_bf16 v[48:51], a[192:195], v[228:231], v[48:51]
    v_mfma_f32_16x16x32_bf16 v[52:55], a[196:199], v[228:231], v[52:55]
    s_waitcnt vmcnt(25)
    v_mfma_f32_16x16x32_bf16 v[36:39], a[200:203], v[232:235], v[36:39]
    buffer_load_dwordx4 v[148:151], v242, s[68:71], s95 offen offset:1024 sc1
    v_mfma_f32_16x16x32_bf16 v[40:43], a[204:207], v[232:235], v[40:43]
    v_mfma_f32_16x16x32_bf16 v[44:47], a[208:211], v[232:235], v[44:47]
    v_mfma_f32_16x16x32_bf16 v[48:51], a[212:215], v[232:235], v[48:51]
    buffer_load_dwordx4 v[152:155], v242, s[68:71], s95 offen offset:2048 sc1
    v_mfma_f32_16x16x32_bf16 v[52:55], a[216:219], v[232:235], v[52:55]
    s_waitcnt vmcnt(26)
    v_mfma_f32_16x16x32_bf16 v[36:39], a[220:223], v[236:239], v[36:39]
    v_mfma_f32_16x16x32_bf16 v[40:43], a[224:227], v[236:239], v[40:43]
    buffer_load_dwordx4 v[156:159], v242, s[68:71], s95 offen offset:3072 sc1
    s_add_u32 s95, s95, 4096
    v_mfma_f32_16x16x32_bf16 v[44:47], a[228:231], v[236:239], v[44:47]
    v_mfma_f32_16x16x32_bf16 v[48:51], a[232:235], v[236:239], v[48:51]
    v_mfma_f32_16x16x32_bf16 v[52:55], a[236:239], v[236:239], v[52:55]
    buffer_load_dwordx4 v[160:163], v242, s[68:71], s95 offen offset:0 sc1
    buffer_load_dwordx4 v[164:167], v242, s[68:71], s95 offen offset:1024 sc1
    buffer_load_dwordx4 v[168:171], v242, s[68:71], s95 offen offset:2048 sc1
    buffer_load_dwordx4 v[172:175], v242, s[68:71], s95 offen offset:3072 sc1
    s_add_u32 s95, s95, 4096
    buffer_load_dwordx4 v[176:179], v242, s[68:71], s95 offen offset:0 sc1
    buffer_load_dwordx4 v[180:183], v242, s[68:71], s95 offen offset:1024 sc1
    buffer_load_dwordx4 v[184:187], v242, s[68:71], s95 offen offset:2048 sc1
    buffer_load_dwordx4 v[188:191], v242, s[68:71], s95 offen offset:3072 sc1
    s_lshl_b32 s12, s6, 12
    s_add_u32 s12, s12, 0xf20000
    v_and_b32 v248, 31, v1
    v_lshlrev_b32 v248, 7, v248
    v_add_u32 v248, s12, v248
    buffer_load_dwordx2 v[246:247], v248, s[68:71], 0 offen sc1
    s_waitcnt vmcnt(35)
    v_mfma_f32_16x16x32_bf16 v[16:19], a[0:3], v[64:67], 0
    v_mfma_f32_16x16x32_bf16 v[20:23], a[4:7], v[64:67], 0
    v_mfma_f32_16x16x32_bf16 v[24:27], a[8:11], v[64:67], 0
    v_mfma_f32_16x16x32_bf16 v[28:31], a[12:15], v[64:67], 0
    v_mfma_f32_16x16x32_bf16 v[32:35], a[16:19], v[64:67], 0
    s_waitcnt vmcnt(34)
    v_mfma_f32_16x16x32_bf16 v[16:19], a[20:23], v[68:71], v[16:19]
    v_mfma_f32_16x16x32_bf16 v[20:23], a[24:27], v[68:71], v[20:23]
    v_mfma_f32_16x16x32_bf16 v[24:27], a[28:31], v[68:71], v[24:27]
    v_mfma_f32_16x16x32_bf16 v[28:31], a[32:35], v[68:71], v[28:31]
    v_mfma_f32_16x16x32_bf16 v[32:35], a[36:39], v[68:71], v[32:35]
    s_waitcnt vmcnt(33)
    v_mfma_f32_16x16x32_bf16 v[16:19], a[40:43], v[72:75], v[16:19]
    ds_write_b128 v13, v[36:39] offset:0
    v_mfma_f32_16x16x32_bf16 v[20:23], a[44:47], v[72:75], v[20:23]
    ds_write_b128 v13, v[40:43] offset:1024
    v_mfma_f32_16x16x32_bf16 v[24:27], a[48:51], v[72:75], v[24:27]
    ds_write_b128 v13, v[44:47] offset:2048
    v_mfma_f32_16x16x32_bf16 v[28:31], a[52:55], v[72:75], v[28:31]
    ds_write_b128 v13, v[48:51] offset:3072
    v_mfma_f32_16x16x32_bf16 v[32:35], a[56:59], v[72:75], v[32:35]
    ds_write_b128 v13, v[52:55] offset:4096
    s_waitcnt vmcnt(32)
    v_mfma_f32_16x16x32_bf16 v[16:19], a[60:63], v[76:79], v[16:19]
    v_mfma_f32_16x16x32_bf16 v[20:23], a[64:67], v[76:79], v[20:23]
    v_mfma_f32_16x16x32_bf16 v[24:27], a[68:71], v[76:79], v[24:27]
    v_mfma_f32_16x16x32_bf16 v[28:31], a[72:75], v[76:79], v[28:31]
    v_mfma_f32_16x16x32_bf16 v[32:35], a[76:79], v[76:79], v[32:35]
    s_waitcnt vmcnt(31)
    v_mfma_f32_16x16x32_bf16 v[16:19], a[80:83], v[80:83], v[16:19]
    v_mfma_f32_16x16x32_bf16 v[20:23], a[84:87], v[80:83], v[20:23]
    v_mfma_f32_16x16x32_bf16 v[24:27], a[88:91], v[80:83], v[24:27]
    v_mfma_f32_16x16x32_bf16 v[28:31], a[92:95], v[80:83], v[28:31]
    v_mfma_f32_16x16x32_bf16 v[32:35], a[96:99], v[80:83], v[32:35]
    s_waitcnt vmcnt(30)
    v_mfma_f32_16x16x32_bf16 v[16:19], a[100:103], v[84:87], v[16:19]
    v_mfma_f32_16x16x32_bf16 v[20:23], a[104:107], v[84:87], v[20:23]
    v_mfma_f32_16x16x32_bf16 v[24:27], a[108:111], v[84:87], v[24:27]
    v_mfma_f32_16x16x32_bf16 v[28:31], a[112:115], v[84:87], v[28:31]
    v_mfma_f32_16x16x32_bf16 v[32:35], a[116:119], v[84:87], v[32:35]
    s_waitcnt vmcnt(29)
    v_mfma_f32_16x16x32_bf16 v[16:19], a[120:123], v[88:91], v[16:19]
    v_mfma_f32_16x16x32_bf16 v[20:23], a[124:127], v[88:91], v[20:23]
    v_mfma_f32_16x16x32_bf16 v[24:27], a[128:131], v[88:91], v[24:27]
    v_mfma_f32_16x16x32_bf16 v[28:31], a[132:135], v[88:91], v[28:31]
    v_mfma_f32_16x16x32_bf16 v[32:35], a[136:139], v[88:91], v[32:35]
    s_waitcnt vmcnt(28)
    v_mfma_f32_16x16x32_bf16 v[16:19], a[140:143], v[92:95], v[16:19]
    v_mfma_f32_16x16x32_bf16 v[20:23], a[144:147], v[92:95], v[20:23]
    v_mfma_f32_16x16x32_bf16 v[24:27], a[148:151], v[92:95], v[24:27]
    v_mfma_f32_16x16x32_bf16 v[28:31], a[152:155], v[92:95], v[28:31]
    v_mfma_f32_16x16x32_bf16 v[32:35], a[156:159], v[92:95], v[32:35]
    s_waitcnt vmcnt(27)
    v_mfma_f32_16x16x32_bf16 v[16:19], a[160:163], v[96:99], v[16:19]
    v_mfma_f32_16x16x32_bf16 v[20:23], a[164:167], v[96:99], v[20:23]
    v_mfma_f32_16x16x32_bf16 v[24:27], a[168:171], v[96:99], v[24:27]
    v_mfma_f32_16x16x32_bf16 v[28:31], a[172:175], v[96:99], v[28:31]
    v_mfma_f32_16x16x32_bf16 v[32:35], a[176:179], v[96:99], v[32:35]
    s_waitcnt vmcnt(26)
    v_mfma_f32_16x16x32_bf16 v[16:19], a[180:183], v[100:103], v[16:19]
    v_mfma_f32_16x16x32_bf16 v[20:23], a[184:187], v[100:103], v[20:23]
    v_mfma_f32_16x16x32_bf16 v[24:27], a[188:191], v[100:103], v[24:27]
    v_mfma_f32_16x16x32_bf16 v[28:31], a[192:195], v[100:103], v[28:31]
    v_mfma_f32_16x16x32_bf16 v[32:35], a[196:199], v[100:103], v[32:35]
    s_waitcnt vmcnt(25)
    v_mfma_f32_16x16x32_bf16 v[16:19], a[200:203], v[104:107], v[16:19]
    v_mfma_f32_16x16x32_bf16 v[20:23], a[204:207], v[104:107], v[20:23]
    v_mfma_f32_16x16x32_bf16 v[24:27], a[208:211], v[104:107], v[24:27]
    v_mfma_f32_16x16x32_bf16 v[28:31], a[212:215], v[104:107], v[28:31]
    v_mfma_f32_16x16x32_bf16 v[32:35], a[216:219], v[104:107], v[32:35]
    s_waitcnt vmcnt(24)
    v_mfma_f32_16x16x32_bf16 v[16:19], a[220:223], v[108:111], v[16:19]
    v_mfma_f32_16x16x32_bf16 v[20:23], a[224:227], v[108:111], v[20:23]
    v_mfma_f32_16x16x32_bf16 v[24:27], a[228:231], v[108:111], v[24:27]
    v_mfma_f32_16x16x32_bf16 v[28:31], a[232:235], v[108:111], v[28:31]
    v_mfma_f32_16x16x32_bf16 v[32:35], a[236:239], v[108:111], v[32:35]
    s_waitcnt vmcnt(13)
    v_lshlrev_b32 v192, 16, v122
    v_and_b32 v193, 0xffff0000, v122
    v_lshlrev_b32 v194, 16, v123
    v_and_b32 v195, 0xffff0000, v123
    v_lshlrev_b32 v196, 16, v124
    v_and_b32 v197, 0xffff0000, v124
    v_lshlrev_b32 v198, 16, v125
    v_and_b32 v199, 0xffff0000, v125
    v_lshlrev_b32 v200, 16, v126
    v_and_b32 v201, 0xffff0000, v126
    v_lshlrev_b32 v202, 16, v127
    v_and_b32 v203, 0xffff0000, v127
    v_lshlrev_b32 v204, 16, v128
    v_and_b32 v205, 0xffff0000, v128
    v_lshlrev_b32 v206, 16, v129
    v_and_b32 v207, 0xffff0000, v129
    v_lshlrev_b32 v208, 16, v130
    v_and_b32 v209, 0xffff0000, v130
    v_lshlrev_b32 v210, 16, v131
    v_and_b32 v211, 0xffff0000, v131
    s_waitcnt vmcnt(0)
    s_mov_b32 s14, 20000
L_poll_24:
    v_cmp_eq_u64 vcc, s[10:11], v[246:247]
    s_nop 0
    s_cmp_eq_u64 vcc, -1
    s_cbranch_scc1 L_pollok_25
    s_sub_u32 s14, s14, 1
    s_cmp_eq_u32 s14, 0
    s_cbranch_scc1 L_pollok_25
    s_sleep 1
    buffer_load_dwordx2 v[246:247], v248, s[68:71], 0 offen sc1
    s_waitcnt vmcnt(0)
    s_branch L_poll_24
L_pollok_25:
    s_mov_b32 s80, 131072
    s_mov_b32 s81, 262144
    buffer_load_dwordx4 v[212:215], v6, s[68:71], 0 offen sc1
    buffer_load_dwordx4 v[216:219], v6, s[68:71], s80 offen sc1
    s_mov_b64 exec, 0xffffffff
    buffer_load_dwordx4 v[220:223], v6, s[68:71], s81 offen sc1
    s_mov_b64 exec, -1
    s_waitcnt vmcnt(15)
    v_mfma_f32_16x16x32_bf16 v[36:39], a[0:3], v[144:147], v[192:195]
    v_mfma_f32_16x16x32_bf16 v[40:43], a[4:7], v[144:147], v[196:199]
    v_mfma_f32_16x16x32_bf16 v[44:47], a[8:11], v[144:147], v[200:203]
    v_mfma_f32_16x16x32_bf16 v[48:51], a[12:15], v[144:147], v[204:207]
    v_mfma_f32_16x16x32_bf16 v[52:55], a[16:19], v[144:147], v[208:211]
    s_waitcnt vmcnt(14)
    v_mfma_f32_16x16x32_bf16 v[36:39], a[20:23], v[148:151], v[36:39]
    v_mfma_f32_16x16x32_bf16 v[40:43], a[24:27], v[148:151], v[40:43]
    v_mfma_f32_16x16x32_bf16 v[44:47], a[28:31], v[148:151], v[44:47]
    v_mfma_f32_16x16x32_bf16 v[48:51], a[32:35], v[148:151], v[48:51]
    v_mfma_f32_16x16x32_bf16 v[52:55], a[36:39], v[148:151], v[52:55]
    s_waitcnt vmcnt(13)
    v_mfma_f32_16x16x32_bf16 v[36:39], a[40:43], v[152:155], v[36:39]
    ds_write_b128 v14, v[16:19] offset:0
    v_mfma_f32_16x16x32_bf16 v[40:43], a[44:47], v[152:155], v[40:43]
    ds_write_b128 v14, v[20:23] offset:1024
    v_mfma_f32_16x16x32_bf16 v[44:47], a[48:51], v[152:155], v[44:47]
    ds_write_b128 v14, v[24:27] offset:2048
    v_mfma_f32_16x16x32_bf16 v[48:51], a[52:55], v[152:155], v[48:51]
    ds_write_b128 v14, v[28:31] offset:3072
    v_mfma_f32_16x16x32_bf16 v[52:55], a[56:59], v[152:155], v[52:55]
    ds_write_b128 v14, v[32:35] offset:4096
    s_waitcnt vmcnt(12)
    v_mfma_f32_16x16x32_bf16 v[36:39], a[60:63], v[156:159], v[36:39]
    v_sub_f32 v58, 1.0, v132
    v_mfma_f32_16x16x32_bf16 v[40:43], a[64:67], v[156:159], v[40:43]
    v_mov_b32 v56, v132
    v_mfma_f32_16x16x32_bf16 v[44:47], a[68:71], v[156:159], v[44:47]
    v_cvt_pk_bf16_f32 v58, v58, v58
    v_mfma_f32_16x16x32_bf16 v[48:51], a[72:75], v[156:159], v[48:51]
    v_mov_b32 v57, v132
    v_mfma_f32_16x16x32_bf16 v[52:55], a[76:79], v[156:159], v[52:55]
    v_lshlrev_b32 v58, 16, v58
    s_waitcnt vmcnt(11)
    v_mfma_f32_16x16x32_bf16 v[36:39], a[80:83], v[160:163], v[36:39]
    v_lshlrev_b32 v64, 16, v112
    v_mfma_f32_16x16x32_bf16 v[40:43], a[84:87], v[160:163], v[40:43]
    v_and_b32 v65, 0xffff0000, v112
    v_mfma_f32_16x16x32_bf16 v[44:47], a[88:91], v[160:163], v[44:47]
    v_lshlrev_b32 v66, 16, v113
    v_mfma_f32_16x16x32_bf16 v[48:51], a[92:95], v[160:163], v[48:51]
    v_and_b32 v67, 0xffff0000, v113
    v_mfma_f32_16x16x32_bf16 v[52:55], a[96:99], v[160:163], v[52:55]
    v_lshlrev_b32 v68, 16, v114
    s_waitcnt vmcnt(10)
    v_mfma_f32_16x16x32_bf16 v[36:39], a[100:103], v[164:167], v[36:39]
    v_and_b32 v69, 0xffff0000, v114
    v_mfma_f32_16x16x32_bf16 v[40:43], a[104:107], v[164:167], v[40:43]
    v_lshlrev_b32 v70, 16, v115
    v_mfma_f32_16x16x32_bf16 v[44:47], a[108:111], v[164:167], v[44:47]
    v_and_b32 v71, 0xffff0000, v115
    v_mfma_f32_16x16x32_bf16 v[48:51], a[112:115], v[164:167], v[48:51]
    v_lshlrev_b32 v72, 16, v116
    v_mfma_f32_16x16x32_bf16 v[52:55], a[116:119], v[164:167], v[52:55]
    v_and_b32 v73, 0xffff0000, v116
    s_waitcnt vmcnt(9)
    v_mfma_f32_16x16x32_bf16 v[36:39], a[120:123], v[168:171], v[36:39]
    v_lshlrev_b32 v74, 16, v117
    v_mfma_f32_16x16x32_bf16 v[40:43], a[124:127], v[168:171], v[40:43]
    v_and_b32 v75, 0xffff0000, v117
    v_mfma_f32_16x16x32_bf16 v[44:47], a[128:131], v[168:171], v[44:47]
    v_lshlrev_b32 v76, 16, v118
    v_mfma_f32_16x16x32_bf16 v[48:51], a[132:135], v[168:171], v[48:51]
    v_and_b32 v77, 0xffff0000, v118
    v_mfma_f32_16x16x32_bf16 v[52:55], a[136:139], v[168:171], v[52:55]
    v_lshlrev_b32 v78, 16, v119
    s_waitcnt vmcnt(8)
    v_mfma_f32_16x16x32_bf16 v[36:39], a[140:143], v[172:175], v[36:39]
    v_and_b32 v79, 0xffff0000, v119
    v_mfma_f32_16x16x32_bf16 v[40:43], a[144:147], v[172:175], v[40:43]
    v_lshlrev_b32 v80, 16, v120
    v_mfma_f32_16x16x32_bf16 v[44:47], a[148:151], v[172:175], v[44:47]
    v_and_b32 v81, 0xffff0000, v120
    v_mfma_f32_16x16x32_bf16 v[48:51], a[152:155], v[172:175], v[48:51]
    v_lshlrev_b32 v82, 16, v121
    v_mfma_f32_16x16x32_bf16 v[52:55], a[156:159], v[172:175], v[52:55]
    v_and_b32 v83, 0xffff0000, v121
    s_waitcnt vmcnt(7)
    v_mfma_f32_16x16x32_bf16 v[36:39], a[160:163], v[176:179], v[36:39]
    v_mov_b32 v59, v58
    v_mfma_f32_16x16x32_bf16 v[40:43], a[164:167], v[176:179], v[40:43]
    v_mul_f32 v64, v64, v56
    v_mfma_f32_16x16x32_bf16 v[44:47], a[168:171], v[176:179], v[44:47]
    v_mul_f32 v65, v65, v56
    v_mfma_f32_16x16x32_bf16 v[48:51], a[172:175], v[176:179], v[48:51]
    v_mul_f32 v66, v66, v56
    v_mfma_f32_16x16x32_bf16 v[52:55], a[176:179], v[176:179], v[52:55]
    v_mul_f32 v67, v67, v56
    s_waitcnt vmcnt(6)
    v_mfma_f32_16x16x32_bf16 v[36:39], a[180:183], v[180:183], v[36:39]
    v_mul_f32 v68, v68, v56
    v_mfma_f32_16x16x32_bf16 v[40:43], a[184:187], v[180:183], v[40:43]
    v_mul_f32 v69, v69, v56
    v_mfma_f32_16x16x32_bf16 v[44:47], a[188:191], v[180:183], v[44:47]
    v_mul_f32 v70, v70, v56
    v_mfma_f32_16x16x32_bf16 v[48:51], a[192:195], v[180:183], v[48:51]
    v_mul_f32 v71, v71, v56
    v_mfma_f32_16x16x32_bf16 v[52:55], a[196:199], v[180:183], v[52:55]
    v_mul_f32 v72, v72, v56
    s_waitcnt vmcnt(5)
    v_mfma_f32_16x16x32_bf16 v[36:39], a[200:203], v[184:187], v[36:39]
    v_mul_f32 v73, v73, v56
    v_mfma_f32_16x16x32_bf16 v[40:43], a[204:207], v[184:187], v[40:43]
    v_mul_f32 v74, v74, v56
    v_mfma_f32_16x16x32_bf16 v[44:47], a[208:211], v[184:187], v[44:47]
    v_mul_f32 v75, v75, v56
    v_mfma_f32_16x16x32_bf16 v[48:51], a[212:215], v[184:187], v[48:51]
    v_mul_f32 v76, v76, v56
    v_mfma_f32_16x16x32_bf16 v[52:55], a[216:219], v[184:187], v[52:55]
    v_mul_f32 v77, v77, v56
    s_waitcnt vmcnt(4)
    v_mfma_f32_16x16x32_bf16 v[36:39], a[220:223], v[188:191], v[36:39]
    v_mul_f32 v78, v78, v56
    v_mfma_f32_16x16x32_bf16 v[40:43], a[224:227], v[188:191], v[40:43]
    v_mul_f32 v79, v79, v56
    v_mfma_f32_16x16x32_bf16 v[44:47], a[228:231], v[188:191], v[44:47]
    v_mul_f32 v80, v80, v56
    v_mfma_f32_16x16x32_bf16 v[48:51], a[232:235], v[188:191], v[48:51]
    v_mul_f32 v81, v81, v56
    v_mfma_f32_16x16x32_bf16 v[52:55], a[236:239], v[188:191], v[52:55]
    v_mul_f32 v82, v82, v56
    v_mul_f32 v83, v83, v56
    s_waitcnt lgkmcnt(0)
    s_barrier
    ds_read_b128 v[144:147], v15 offset:0
    ds_read_b128 v[148:151], v15 offset:1024
    ds_read_b128 v[152:155], v15 offset:2048
    ds_read_b128 v[156:159], v15 offset:3072
    ds_read_b128 v[160:163], v15 offset:4096
    ds_read_b128 v[164:167], v15 offset:5120
    ds_read_b128 v[168:171], v15 offset:6144
    ds_read_b128 v[172:175], v15 offset:7168
    ds_read_b128 v[176:179], v15 offset:8192
    ds_read_b128 v[180:183], v15 offset:9216
    ds_read_b128 v[184:187], v15 offset:10240
    ds_read_b128 v[188:191], v15 offset:11264
    ds_read_b128 v[192:195], v15 offset:12288
    ds_read_b128 v[196:199], v15 offset:13312
    ds_read_b128 v[200:203], v15 offset:14336
    s_waitcnt vmcnt(0)
    ds_write_b128 v7, v[212:215]
    ds_write_b128 v7, v[216:219] offset:1024
    s_mov_b64 exec, 0xffffffff
    ds_write_b128 v7, v[220:223] offset:2048
    s_mov_b64 exec, -1
    ds_read_b64_tr_b16 v[224:225], v8 offset:0
    ds_read_b64_tr_b16 v[226:227], v8 offset:512
    ds_read_b64_tr_b16 v[228:229], v8 offset:1024
    ds_read_b64_tr_b16 v[230:231], v8 offset:1536
    ds_read_b64_tr_b16 v[232:233], v8 offset:2048
    s_waitcnt lgkmcnt(15)
    v_pk_add_f32 v[36:37], v[36:37], v[144:145]
    v_pk_add_f32 v[38:39], v[38:39], v[146:147]
    v_pk_add_f32 v[40:41], v[40:41], v[148:149]
    v_pk_add_f32 v[42:43], v[42:43], v[150:151]
    v_pk_add_f32 v[44:45], v[44:45], v[152:153]
    v_pk_add_f32 v[46:47], v[46:47], v[154:155]
    v_pk_add_f32 v[48:49], v[48:49], v[156:157]
    v_pk_add_f32 v[50:51], v[50:51], v[158:159]
    v_pk_add_f32 v[52:53], v[52:53], v[160:161]
    v_pk_add_f32 v[54:55], v[54:55], v[162:163]
    s_waitcnt lgkmcnt(13)
    v_pk_add_f32 v[36:37], v[36:37], v[164:165]
    v_pk_add_f32 v[38:39], v[38:39], v[166:167]
    v_pk_add_f32 v[40:41], v[40:41], v[168:169]
    v_pk_add_f32 v[42:43], v[42:43], v[170:171]
    v_pk_add_f32 v[44:45], v[44:45], v[172:173]
    v_pk_add_f32 v[46:47], v[46:47], v[174:175]
    v_pk_add_f32 v[48:49], v[48:49], v[176:177]
    v_pk_add_f32 v[50:51], v[50:51], v[178:179]
    v_pk_add_f32 v[52:53], v[52:53], v[180:181]
    v_pk_add_f32 v[54:55], v[54:55], v[182:183]
    s_waitcnt lgkmcnt(8)
    v_pk_add_f32 v[36:37], v[36:37], v[184:185]
    v_pk_add_f32 v[38:39], v[38:39], v[186:187]
    v_pk_add_f32 v[40:41], v[40:41], v[188:189]
    v_pk_add_f32 v[42:43], v[42:43], v[190:191]
    v_pk_add_f32 v[44:45], v[44:45], v[192:193]
    v_pk_add_f32 v[46:47], v[46:47], v[194:195]
    v_pk_add_f32 v[48:49], v[48:49], v[196:197]
    v_pk_add_f32 v[50:51], v[50:51], v[198:199]
    v_pk_add_f32 v[52:53], v[52:53], v[200:201]
    v_pk_add_f32 v[54:55], v[54:55], v[202:203]
    v_pk_mul_f32 v[36:37], v[36:37], v[58:59]
    v_pk_mul_f32 v[38:39], v[38:39], v[58:59]
    v_pk_mul_f32 v[40:41], v[40:41], v[58:59]
    v_pk_mul_f32 v[42:43], v[42:43], v[58:59]
    v_pk_mul_f32 v[44:45], v[44:45], v[58:59]
    v_pk_mul_f32 v[46:47], v[46:47], v[58:59]
    v_pk_mul_f32 v[48:49], v[48:49], v[58:59]
    v_pk_mul_f32 v[50:51], v[50:51], v[58:59]
    v_pk_mul_f32 v[52:53], v[52:53], v[58:59]
    v_pk_mul_f32 v[54:55], v[54:55], v[58:59]
    s_waitcnt lgkmcnt(0)
    v_lshlrev_b32 v84, 16, v224
    v_and_b32 v85, 0xffff0000, v224
    v_lshlrev_b32 v86, 16, v225
    v_and_b32 v87, 0xffff0000, v225
    v_pk_fma_f32 v[64:65], v[64:65], v[84:85], v[36:37]
    v_pk_fma_f32 v[66:67], v[66:67], v[86:87], v[38:39]
    v_cvt_pk_bf16_f32 v112, v64, v65
    v_cvt_pk_bf16_f32 v113, v66, v67
    buffer_store_dwordx2 v[112:113], v3, s[72:75], 0 offen offset:0
    v_lshlrev_b32 v88, 16, v226
    v_and_b32 v89, 0xffff0000, v226
    v_lshlrev_b32 v90, 16, v227
    v_and_b32 v91, 0xffff0000, v227
    v_pk_fma_f32 v[68:69], v[68:69], v[88:89], v[40:41]
    v_pk_fma_f32 v[70:71], v[70:71], v[90:91], v[42:43]
    v_cvt_pk_bf16_f32 v114, v68, v69
    v_cvt_pk_bf16_f32 v115, v70, v71
    buffer_store_dwordx2 v[114:115], v3, s[72:75], 0 offen offset:32
    v_lshlrev_b32 v92, 16, v228
    v_and_b32 v93, 0xffff0000, v228
    v_lshlrev_b32 v94, 16, v229
    v_and_b32 v95, 0xffff0000, v229
    v_pk_fma_f32 v[72:73], v[72:73], v[92:93], v[44:45]
    v_pk_fma_f32 v[74:75], v[74:75], v[94:95], v[46:47]
    v_cvt_pk_bf16_f32 v116, v72, v73
    v_cvt_pk_bf16_f32 v117, v74, v75
    buffer_store_dwordx2 v[116:117], v3, s[72:75], 0 offen offset:64
    v_lshlrev_b32 v96, 16, v230
    v_and_b32 v97, 0xffff0000, v230
    v_lshlrev_b32 v98, 16, v231
    v_and_b32 v99, 0xffff0000, v231
    v_pk_fma_f32 v[76:77], v[76:77], v[96:97], v[48:49]
    v_pk_fma_f32 v[78:79], v[78:79], v[98:99], v[50:51]
    v_cvt_pk_bf16_f32 v118, v76, v77
    v_cvt_pk_bf16_f32 v119, v78, v79
    buffer_store_dwordx2 v[118:119], v3, s[72:75], 0 offen offset:96
    v_lshlrev_b32 v100, 16, v232
    v_and_b32 v101, 0xffff0000, v232
    v_lshlrev_b32 v102, 16, v233
    v_and_b32 v103, 0xffff0000, v233
    v_pk_fma_f32 v[80:81], v[80:81], v[100:101], v[52:53]
    v_pk_fma_f32 v[82:83], v[82:83], v[102:103], v[54:55]
    v_cvt_pk_bf16_f32 v120, v80, v81
    v_cvt_pk_bf16_f32 v121, v82, v83
    buffer_store_dwordx2 v[120:121], v3, s[72:75], 0 offen offset:128
END_gated_mix__ssm_conv_h3__dense_activation_gelu__prompt_kernel:
    s_endpgm
.p2align 12
.fill 1024, 4, 0xbf800000
.section .rodata,"a"
.p2align 6
.amdhsa_kernel gated_mix__ssm_conv_h3__dense_activation_gelu__prompt_kernel
  .amdhsa_next_free_vgpr 512
  .amdhsa_next_free_sgpr 102
  .amdhsa_accum_offset 256
  .amdhsa_group_segment_fixed_size 0
  .amdhsa_kernarg_size 120
  .amdhsa_user_sgpr_count 2
  .amdhsa_user_sgpr_kernarg_segment_ptr 1
  .amdhsa_system_sgpr_workgroup_id_x 1
.end_amdhsa_kernel
```
